```python
import torch

def _softmax(x, axis=-1):
    return torch.softmax(x, dim=axis)

def _gelu(x):
    return torch.nn.functional.gelu(x, approximate='tanh')

def _silu(x):
    return torch.nn.functional.silu(x)

def _sigmoid(x):
    return torch.sigmoid(x)

def _layernorm(x, axis=-1, eps=1e-05):
    m = x.mean(dim=axis, keepdim=True)
    v = x.var(dim=axis, keepdim=True, unbiased=False)
    return (x - m) / torch.sqrt(v + eps)

def _scatter_add(tgt, idx, src, axis=0):
    return tgt.clone().index_add_(axis, idx, src)

def _segment_sum(src, seg, n):
    out = torch.zeros((n,) + src.shape[1:], dtype=src.dtype)
    return out.index_add_(0, seg, src)

def _pad(x, pw):
    flat = tuple((v for pair in reversed(pw) for v in pair))
    return torch.nn.functional.pad(x, flat)
kernel_name = 'adaLN_cond__ssm_conv_h3__glu_gated_bilinear__prompt'

def setup_inputs():

    _w = lambda a: (lambda t: t.to(torch.bfloat16) if t.is_floating_point() else t)(torch.as_tensor(a))

    def _A_setup():
        B, S, D = (1, 2048, 512)
        ks = 4
        return {'q': _w((lambda *s: torch.randn(*s, dtype=torch.bfloat16) * 0.05)(B, S, D)), 'k': _w((lambda *s: torch.randn(*s, dtype=torch.bfloat16) * 0.8)(B, S, D)), 'v': _w((lambda *s: torch.randn(*s, dtype=torch.bfloat16) * 0.8)(B, S, D)), 'shift_k': _w((lambda *s: torch.randn(*s, dtype=torch.bfloat16) * 0.8)(D, ks) * 0.5), 'ssm_k': _w((lambda *s: torch.randn(*s, dtype=torch.bfloat16) * 0.8)(D, S) * (1.0 / S ** 0.5)), 'ssm_D': _w((lambda *s: torch.randn(*s, dtype=torch.bfloat16) * 0.8)(D))}
    _A_in = _A_setup()

    def _B_setup():
        B, S, D, F = (1, 2048, 512, 1792)
        return {'x': _w((lambda *s: torch.randn(*s, dtype=torch.bfloat16) * 0.05)(B, S, D)), 'w_gate': _w((lambda *s: torch.randn(*s, dtype=torch.bfloat16) * 0.8)(D, F) * D ** (-0.5)), 'w_up': _w((lambda *s: torch.randn(*s, dtype=torch.bfloat16) * 0.8)(D, F) * D ** (-0.5)), 'w_down': _w((lambda *s: torch.randn(*s, dtype=torch.bfloat16) * 0.8)(F, D) * F ** (-0.5))}
    _B_in = _B_setup()
    return {'A_q': _A_in['q'], 'A_k': _A_in['k'], 'A_v': _A_in['v'], 'A_shift_k': _A_in['shift_k'], 'A_ssm_k': _A_in['ssm_k'], 'A_ssm_D': _A_in['ssm_D'], 'B_x': _B_in['x'], 'B_w_gate': _B_in['w_gate'], 'B_w_up': _B_in['w_up'], 'B_w_down': _B_in['w_down'], 'c': _w((lambda *s: torch.randn(*s, dtype=torch.bfloat16) * 0.2)(1, 512) * 8.0), 'w_mod': _w((lambda *s: torch.randn(*s, dtype=torch.bfloat16) * 0.2)(512, 6 * 512) * 512 ** (-0.5) * 8.0)}

def reference(A_q, A_k, A_v, A_shift_k, A_ssm_k, A_ssm_D, B_x, B_w_gate, B_w_up, B_w_down, c, w_mod):

    def _A_ref(q, k, v, shift_k, ssm_k, ssm_D):
        B, S, D = q.shape
        ks = shift_k.shape[-1]
        k_pad = _pad(k, ((0, 0), (ks - 1, 0), (0, 0)))
        k_shift = torch.zeros_like(k)
        for t in range(ks):
            k_shift = k_shift + k_pad[:, t:t + S, :] * shift_k[:, ks - 1 - t][None, None, :]
        kv = k_shift * v
        L = 2 * S
        kv_pad = _pad(kv, ((0, 0), (0, S), (0, 0)))
        kf_pad = _pad(ssm_k, ((0, 0), (0, S)))
        kv_f = (lambda x, axes=(-2, -1): torch.fft.rfft2(x.float(), dim=axes))(kv_pad[:, None, :, :], axes=(1, 2))
        kf_f = (lambda x, axes=(-2, -1): torch.fft.rfft2(x.float(), dim=axes))(kf_pad[:, None, :], axes=(1, 2))
        kf_f = (lambda x, *d: x.permute(*d))(kf_f, 1, 2, 0)
        y_f = kv_f * kf_f[None, :, :, :]
        y = (lambda x, s, axes=(-2, -1): torch.fft.irfft2(x, s=s, dim=axes).to(torch.bfloat16))(y_f, (1, L), axes=(1, 2))[:, 0, :S, :]
        y = y + kv * ssm_D[None, None, :]
        return q * y

    def _B_ref(x, w_gate, w_up, w_down):
        g = torch.einsum('bsd,df->bsf', x, w_gate)
        u = torch.einsum('bsd,df->bsf', x, w_up)
        h = g * u
        return torch.einsum('bsf,fd->bsd', h, w_down)
    x = A_q
    mod = (_silu(c) @ w_mod).reshape(c.shape[0], 6, 1, -1)
    sa, ca, ga, sb, cb, gb = (mod[:, 0].clone(), mod[:, 1].clone(), mod[:, 2].clone(), mod[:, 3].clone(), mod[:, 4].clone(), mod[:, 5].clone())
    h = _layernorm(x, axis=-1) * (1 + ca) + sa
    x = x + ga * _A_ref(h, A_k, A_v, A_shift_k, A_ssm_k, A_ssm_D)
    h = _layernorm(x, axis=-1) * (1 + cb) + sb
    x = x + gb * _B_ref(h, B_w_gate, B_w_up, B_w_down)
    return x
```

```asm
; @launch grid=(256,1,1) block=(256,1,1) lds=163840
.amdgcn_target "amdgcn-amd-amdhsa--gfx950"
.text
.globl adaLN_cond__ssm_conv_h3__glu_gated_bilinear__prompt_kernel
.p2align 13
.fill 704, 4, 0xbf800000
.p2align 8
.type adaLN_cond__ssm_conv_h3__glu_gated_bilinear__prompt_kernel,@function
adaLN_cond__ssm_conv_h3__glu_gated_bilinear__prompt_kernel:
  s_cmp_ge_u32 s2, 256
  s_cbranch_scc1 L_end
  s_load_dwordx2 s[8:9], s[0:1], 8
  s_load_dwordx2 s[12:13], s[0:1], 16
  s_load_dwordx2 s[16:17], s[0:1], 24
  s_load_dwordx2 s[44:45], s[0:1], 112
  s_load_dwordx2 s[32:33], s[0:1], 80
  s_load_dwordx2 s[36:37], s[0:1], 88
  s_load_dwordx2 s[4:5], s[0:1], 0
  s_load_dwordx2 s[20:21], s[0:1], 32
  s_load_dwordx2 s[28:29], s[0:1], 72
  s_load_dwordx2 s[40:41], s[0:1], 96
  s_load_dwordx2 s[52:53], s[0:1], 56
  s_load_dwordx2 s[54:55], s[0:1], 64
  s_load_dwordx2 s[48:49], s[0:1], 40
  s_and_b32 s3, s2, 7
  s_lshr_b32 s56, s2, 3
  v_lshrrev_b32 v249, 6, v0
  v_and_b32 v255, 63, v0
  v_readfirstlane_b32 s57, v249
  v_lshlrev_b32 v254, 4, v255
  v_lshlrev_b32 v250, 4, v0
  s_mov_b32 s10, 2097152
  s_mov_b32 s11, 0x20000
  s_mov_b32 s14, 2097152
  s_mov_b32 s15, 0x20000
  s_mov_b32 s18, 4096
  s_mov_b32 s19, 0x20000
  s_mov_b32 s46, 27262976
  s_mov_b32 s47, 0x20000
  s_mov_b32 s34, 1024
  s_mov_b32 s35, 0x20000
  s_mov_b32 s38, 3145728
  s_mov_b32 s39, 0x20000
  s_mov_b32 s6, 2097152
  s_mov_b32 s7, 0x20000
  s_mov_b32 s22, 2097152
  s_mov_b32 s23, 0x20000
  s_mov_b32 s30, 1835008
  s_mov_b32 s31, 0x20000
  s_mov_b32 s42, 2097152
  s_mov_b32 s43, 0x20000
  s_mov_b32 s26, 1835008
  s_mov_b32 s27, 0x20000
  s_mov_b32 s50, 1024
  s_mov_b32 s51, 0x20000
  v_lshrrev_b32 v252, 5, v255
  v_and_b32 v251, 31, v255
  s_mov_b32 s58, 0
  s_movk_i32 s67, 0x1000
  s_lshl_b32 s59, s56, 16
  s_lshl_b32 s60, s3, 7
  s_lshl_b32 s61, s57, 5
  s_add_u32 s60, s60, s61
  s_add_u32 s59, s59, s60
  v_lshrrev_b32 v249, 3, v255
  v_and_b32 v248, 7, v255
  v_lshlrev_b32 v239, 13, v249
  v_lshl_add_u32 v239, v248, 2, v239
  v_add_u32 v239, s59, v239
  v_subrev_u32 v238, 3072, v239
  s_lshl_b32 s61, s60, 2
  v_lshlrev_b32 v237, 4, v248
  v_add_u32 v237, s61, v237
  v_mov_b32 v247, 0
  s_waitcnt lgkmcnt(0)
  buffer_load_dword v253, v247, s[44:47], 0 offen sc1
  buffer_load_dwordx4 v[26:29], v237, s[16:19], 0 offen
  buffer_load_dword v6, v238, s[8:11], 0 offen offset:0
  buffer_load_dword v7, v238, s[8:11], 0 offen offset:1024
  buffer_load_dword v8, v238, s[8:11], 0 offen offset:2048
  buffer_load_dword v9, v239, s[8:11], 0 offen offset:0
  buffer_load_dword v10, v239, s[8:11], 0 offen offset:1024
  buffer_load_dword v11, v239, s[8:11], 0 offen offset:2048
  buffer_load_dword v12, v239, s[8:11], 0 offen offset:3072
  buffer_load_dword v13, v239, s[8:11], s67 offen offset:0
  buffer_load_dword v14, v239, s[8:11], s67 offen offset:1024
  buffer_load_dword v15, v239, s[8:11], s67 offen offset:2048
  buffer_load_dword v16, v239, s[8:11], s67 offen offset:3072
  buffer_load_dword v17, v239, s[12:15], 0 offen offset:0
  buffer_load_dword v18, v239, s[12:15], 0 offen offset:1024
  buffer_load_dword v19, v239, s[12:15], 0 offen offset:2048
  buffer_load_dword v20, v239, s[12:15], 0 offen offset:3072
  buffer_load_dword v21, v239, s[12:15], s67 offen offset:0
  buffer_load_dword v22, v239, s[12:15], s67 offen offset:1024
  s_lshl_b32 s65, s3, 18
  s_lshl_b32 s66, s56, 13
  s_add_u32 s65, s65, s66
  s_add_u32 s65, s65, 1048576
  s_add_u32 s66, s65, 4096
  buffer_load_dwordx4 v[2:5], v250, s[44:47], s65 offen sc1
  buffer_load_dwordx4 v[2:5], v250, s[44:47], s66 offen sc1
  s_lshl_b32 s61, s60, 11
  s_lshl_b32 s62, s56, 7
  s_add_u32 s61, s61, s62
  v_lshlrev_b32 v236, 13, v249
  v_lshl_add_u32 v236, v248, 4, v236
  s_add_u32 s61, s61, 1048576
  v_add_u32 v236, s61, v236
  v_lshlrev_b32 v238, 5, v248
  v_lshl_add_u32 v238, v249, 2, v238
  s_mov_b32 s68, 0x05040100
  s_mov_b32 s69, 0x07060302
  s_mov_b32 s70, 0xffff0000
  s_mov_b32 s71, 0x3f803f80
  s_and_b32 s80, s56, 1
  s_cmp_eq_u32 s80, 0
  s_cselect_b32 s24, s52, s54
  s_cselect_b32 s25, s53, s55
  s_lshl_b32 s72, s3, 6
  s_lshl_b32 s63, s56, 1
  s_add_u32 s72, s72, s63
  s_lshl_b32 s81, s3, 2
  s_add_u32 s81, s81, s57
  s_lshr_b32 s82, s56, 1
  s_lshl_b32 s59, s81, 5
  s_add_u32 s59, s59, s56
  s_lshl_b32 s59, s59, 7
  v_mov_b32 v237, 2147483648
  v_writelane_b32 v237, s59, 0
  s_lshr_b32 s59, s56, 3
  s_lshl_b32 s60, s3, 2
  s_add_u32 s59, s59, s60
  s_lshl_b32 s59, s59, 2
  s_add_u32 s59, s59, s57
  s_lshl_b32 s59, s59, 3
  v_and_b32 v249, 7, v255
  v_add_lshl_u32 v234, v249, s59, 7
  v_and_b32 v249, 7, v255
  v_lshrrev_b32 v248, 3, v255
  v_lshlrev_b32 v233, 4, v249
  v_lshl_add_u32 v233, v248, 12, v233
  s_lshl_b32 s59, s81, 7
  s_add_u32 s59, s59, 589824
  v_add_u32 v233, s59, v233
  v_readlane_b32 s59, v237, 0
  s_mul_i32 s60, s56, 3
  s_min_u32 s61, s57, 2
  s_add_u32 s60, s60, s61
  s_and_b32 s61, s60, 3
  s_lshr_b32 s60, s60, 2
  s_lshl_b32 s60, s60, 5
  s_add_u32 s60, s60, s61
  s_lshl_b32 s61, s3, 2
  s_add_u32 s60, s60, s61
  s_lshl_b32 s60, s60, 7
  s_add_u32 s60, s60, 524288
  s_add_u32 s59, s59, 131072
  v_mov_b32 v249, v237
  v_writelane_b32 v249, s59, 1
  v_writelane_b32 v249, s60, 2
  s_mov_b32 s65, 8388608
  buffer_load_dword v232, v249, s[44:47], s65 offen sc1
  buffer_load_dword v23, v239, s[12:15], s67 offen offset:2048
  buffer_load_dword v24, v239, s[12:15], s67 offen offset:3072
  s_and_b32 s63, s56, 3
  s_lshl_b32 s63, s63, 7
  v_lshrrev_b32 v247, 3, v0
  v_add_u32 v247, s63, v247
  v_lshlrev_b32 v230, 1, v247
  v_mul_u32_u24 v231, 6144, v247
  v_and_b32 v247, 7, v0
  v_lshl_add_u32 v231, v247, 4, v231
  s_lshr_b32 s63, s56, 2
  s_lshl_b32 s63, s63, 10
  s_lshl_b32 s64, s3, 7
  s_add_u32 s63, s63, s64
  s_cmp_lt_u32 s56, 24
  s_cselect_b32 s63, s63, 2147483648
  v_add_u32 v231, s63, v231
  s_lshl_b32 s59, s2, 13
  s_lshl_b32 s60, s57, 11
  s_add_u32 s59, s59, s60
  buffer_load_dwordx4 v[42:45], v254, s[4:7], s59 offen offset:0
  buffer_load_dwordx4 v[46:49], v254, s[4:7], s59 offen offset:1024
  buffer_load_ushort v50, v230, s[32:35], 0 offen offset:0
  buffer_load_ushort v51, v230, s[32:35], 0 offen offset:64
  buffer_load_ushort v52, v230, s[32:35], 0 offen offset:128
  buffer_load_ushort v53, v230, s[32:35], 0 offen offset:192
  s_mov_b32 s64, 0
  buffer_load_dwordx4 v[54:57], v231, s[36:39], s64 offen nt
  s_mov_b32 s64, 196608
  buffer_load_dwordx4 v[58:61], v231, s[36:39], s64 offen nt
  s_mov_b32 s64, 393216
  buffer_load_dwordx4 v[62:65], v231, s[36:39], s64 offen nt
  s_mov_b32 s64, 589824
  buffer_load_dwordx4 v[66:69], v231, s[36:39], s64 offen nt
  v_mov_b32 v70, 0
  v_mov_b32 v71, 0
  v_mov_b32 v72, 0
  v_mov_b32 v73, 0
  v_lshlrev_b32 v247, 4, v251
  v_mul_u32_u24 v249, 4608, v252
  v_add_u32 v247, v247, v249
  ds_write_b128 v247, v[70:73] offset:4096
  v_and_b32 v247, 15, v255
  v_mul_u32_u24 v247, 4160, v247
  ds_write_b128 v247, v[70:73] offset:15360
  s_lshl_b32 s59, s56, 12
  s_lshl_b32 s60, s3, 9
  s_add_u32 s59, s59, s60
  s_add_u32 s59, s59, 589824
  s_cmp_lt_u32 s56, 24
  s_cselect_b32 s59, s59, 2147483648
  s_cmp_eq_u32 s57, 1
  s_cselect_b32 s59, s59, 2147483648
  v_lshlrev_b32 v249, 3, v255
  v_add_u32 v231, s59, v249
  s_lshr_b32 s59, s57, 1
  s_and_b32 s60, s57, 1
  s_lshl_b32 s60, s60, 8
  s_mul_i32 s61, s59, 33280
  s_add_u32 s61, s61, s60
  s_mul_i32 s62, s59, 4608
  s_add_u32 s62, s62, s60
  s_add_u32 s62, s62, 480
  v_and_b32 v249, 7, v255
  v_mul_u32_u24 v230, 4160, v249
  v_bfe_u32 v249, v255, 3, 1
  v_lshrrev_b32 v248, 4, v255
  v_add_u32 v249, v249, v248
  v_lshl_add_u32 v230, v249, 4, v230
  v_add_u32 v230, s61, v230
  v_and_b32 v249, 15, v255
  v_lshlrev_b32 v247, 5, v249
  v_lshlrev_b32 v229, 4, v248
  v_sub_u32 v229, v229, v247
  v_add_u32 v229, s62, v229
  v_and_b32 v228, 1, v248
  v_lshlrev_b32 v228, 12, v228
  v_add_u32 v228, v228, v247
  v_lshrrev_b32 v248, 1, v248
  v_lshl_add_u32 v228, v248, 4, v228
  s_mul_i32 s59, s57, 20480
  s_add_u32 s59, s59, 94208
  v_add_u32 v228, s59, v228
  s_lshr_b32 s86, s56, 2
  s_lshr_b32 s59, s3, 1
  s_lshl_b32 s59, s59, 3
  s_add_u32 s86, s86, s59
  s_and_b32 s87, s56, 3
  s_and_b32 s59, s3, 1
  s_lshl_b32 s59, s59, 2
  s_add_u32 s87, s87, s59
  s_mul_i32 s88, s57, 458752
  s_lshl_b32 s59, s87, 7
  s_add_u32 s88, s88, s59
  v_bfe_u32 v249, v255, 3, 2
  v_lshlrev_b32 v246, 12, v249
  v_lshl_add_u32 v246, v252, 10, v246
  v_bfe_u32 v249, v255, 4, 1
  v_lshlrev_b32 v249, 2, v249
  v_and_b32 v248, 7, v255
  v_xor_b32 v249, v249, v248
  v_lshl_add_u32 v246, v249, 4, v246
  v_add_u32 v245, 1024, v246
  v_bfe_u32 v249, v255, 2, 2
  v_lshlrev_b32 v244, 7, v249
  v_lshl_add_u32 v244, v252, 9, v244
  v_bfe_u32 v249, v255, 3, 1
  s_and_b32 s59, s57, 1
  v_xor_b32 v249, s59, v249
  v_lshl_add_u32 v244, v249, 6, v244
  v_and_b32 v249, 1, v255
  v_lshl_add_u32 v244, v249, 5, v244
  v_bfe_u32 v249, v255, 4, 1
  v_lshl_add_u32 v244, v249, 4, v244
  v_bfe_u32 v249, v255, 1, 1
  v_lshl_add_u32 v244, v249, 3, v244
  s_mul_i32 s89, s57, 20480
  s_add_u32 s89, s89, 81920
  v_add_u32 v244, s89, v244
  v_xor_b32 v243, 64, v244
  s_mul_i32 s53, s82, 229376
  s_lshl_b32 s60, s80, 9
  s_add_u32 s53, s53, s60
  s_add_u32 s53, s53, 11534336
  s_mul_i32 s60, s81, 3072
  s_lshl_b32 s61, s81, 10
  v_lshrrev_b32 v249, 2, v251
  v_lshlrev_b32 v227, 10, v249
  v_add_u32 v227, s60, v227
  v_lshlrev_b32 v247, 15, v249
  v_add_u32 v247, s61, v247
  v_cmp_gt_u32 vcc, 3, v249
  v_mov_b32 v248, 2147483648
  s_nop 0
  v_cndmask_b32 v227, v247, v227, vcc
  v_cmp_gt_u32 vcc, 7, v249
  v_xor_b32 v247, s80, v252
  s_nop 0
  v_cndmask_b32 v227, v248, v227, vcc
  v_lshl_add_u32 v227, v247, 6, v227
  v_and_b32 v247, 3, v251
  v_lshl_add_u32 v227, v247, 4, v227
  v_lshlrev_b32 v226, 6, v249
  v_lshl_add_u32 v226, v247, 2, v226
  v_lshl_add_u32 v226, v252, 9, v226
  v_add_u32 v226, s89, v226
  v_add_u32 v225, 94208, v250
  v_add_u32 v224, 135168, v250
  v_bfe_u32 v249, v255, 2, 1
  v_lshl_add_u32 v223, v249, 10, s89
  v_lshrrev_b32 v249, 3, v255
  v_lshl_add_u32 v223, v249, 7, v223
  v_and_b32 v249, 3, v255
  v_lshl_add_u32 v223, v249, 4, v223
  v_lshl_add_u32 v222, v249, 3, s89
  v_bfe_u32 v249, v255, 4, 1
  v_lshl_add_u32 v222, v249, 5, v222
  v_bfe_u32 v249, v255, 2, 2
  v_lshl_add_u32 v222, v249, 6, v222
  v_lshl_add_u32 v222, v252, 9, v222
  s_lshl_b32 s90, s56, 6
  s_add_u32 s90, s90, s81
  s_lshl_b32 s90, s90, 10
  s_add_u32 s90, s90, 9437184
  s_add_u32 s91, s90, 32768
  s_lshl_b32 s59, s56, 13
  s_lshl_b32 s60, s3, 9
  s_add_u32 s59, s59, s60
  s_add_u32 s59, s59, 8650752
  s_cmp_eq_u32 s57, 0
  s_cselect_b32 s59, s59, 2147483648
  v_lshl_add_u32 v221, v251, 4, s59
  v_lshl_add_u32 v221, v252, 12, v221
  s_lshl_b32 s59, s56, 7
  s_add_u32 s59, s59, 688128
  v_and_b32 v249, 7, v255
  v_lshl_add_u32 v220, v249, 4, s59
  s_lshl_b32 s59, s56, 5
  s_add_u32 s59, s59, s81
  s_lshl_b32 s59, s59, 5
  v_mov_b32 v219, 2147483648
  v_writelane_b32 v219, s59, 0
  s_and_b32 s92, s3, 1
  s_lshl_b32 s92, s92, 3
  s_lshr_b32 s59, s56, 2
  s_add_u32 s92, s92, s59
  s_lshr_b32 s93, s3, 1
  s_lshl_b32 s93, s93, 2
  s_and_b32 s59, s56, 3
  s_add_u32 s93, s93, s59
  s_lshl_b32 s59, s93, 6
  v_add_lshl_u32 v240, v255, s59, 5
  s_lshl_b32 s59, s56, 5
  s_add_u32 s59, s59, s81
  v_lshlrev_b32 v218, 10, v255
  v_add_lshl_u32 v218, v218, s59, 5
  v_mov_b32 v248, 2147483648
  v_cmp_gt_u32 vcc, 4, v255
  s_lshr_b32 s59, s3, 1
  s_lshl_b32 s59, s59, 4
  s_add_u32 s59, s59, s92
  s_lshl_b32 s59, s59, 1
  s_lshr_b32 s60, s57, 1
  s_add_u32 s59, s59, s60
  s_lshl_b32 s59, s59, 5
  v_add_lshl_u32 v217, v251, s59, 5
  v_cndmask_b32 v218, v248, v218, vcc
  s_mul_i32 s94, s93, 229376
  s_lshl_b32 s95, s57, 12
  s_add_u32 s94, s94, s95
  s_add_u32 s94, s94, 11534336
  s_cmp_eq_u32 s57, 0
  s_cbranch_scc1 L_pstub0
L_pback0:
  s_cmp_eq_u32 s57, 1
  s_cbranch_scc1 L_pstub1
L_pback1:
  s_cmp_eq_u32 s57, 2
  s_cbranch_scc1 L_pstub2
L_pback2:
  s_cmp_eq_u32 s57, 3
  s_cbranch_scc1 L_pstub3
L_pback3:
  s_waitcnt vmcnt(33)
  s_mov_b32 s59, 0x9E3779B1
  v_mul_lo_u32 v253, v253, s59
  v_add_u32 v253, 0x7F4A7C15, v253
  s_getreg_b32 s59, hwreg(HW_REG_XCC_ID, 0, 4)
  s_add_u32 s59, s59, 1
  v_xor_b32 v235, s59, v253
  s_waitcnt vmcnt(32)
  v_lshlrev_b32 v92, 16, v26
  v_lshlrev_b32 v93, 16, v28
  v_and_b32 v94, s70, v26
  v_and_b32 v95, s70, v28
  v_lshlrev_b32 v96, 16, v27
  v_lshlrev_b32 v97, 16, v29
  v_and_b32 v98, s70, v27
  v_and_b32 v99, s70, v29
  s_waitcnt vmcnt(29)
  s_lshl_b32 s63, s72, 12
  s_add_u32 s64, s63, 4096
  v_subrev_u32 v247, 16, v250
  v_min_u32 v247, 2147483648, v247
  buffer_load_dwordx4 v[120:123], v250, s[20:23], s63 offen
  buffer_load_dwordx4 v[116:119], v247, s[20:23], s63 offen
  buffer_load_dwordx4 v[128:131], v250, s[20:23], s64 offen
  buffer_load_dwordx4 v[124:127], v247, s[20:23], s64 offen
  s_waitcnt vmcnt(25)
  v_lshlrev_b32 v70, 16, v6
  v_and_b32 v71, s70, v6
  v_lshlrev_b32 v72, 16, v7
  v_and_b32 v73, s70, v7
  v_lshlrev_b32 v74, 16, v8
  v_and_b32 v75, s70, v8
  v_lshlrev_b32 v76, 16, v9
  v_and_b32 v77, s70, v9
  v_lshlrev_b32 v78, 16, v10
  v_and_b32 v79, s70, v10
  v_lshlrev_b32 v80, 16, v11
  v_and_b32 v81, s70, v11
  v_lshlrev_b32 v82, 16, v12
  v_and_b32 v83, s70, v12
  v_lshlrev_b32 v84, 16, v13
  v_and_b32 v85, s70, v13
  v_lshlrev_b32 v86, 16, v14
  v_and_b32 v87, s70, v14
  v_lshlrev_b32 v88, 16, v15
  v_and_b32 v89, s70, v15
  v_lshlrev_b32 v90, 16, v16
  v_and_b32 v91, s70, v16
  v_pk_mul_f32 v[100:101], v[70:71], v[98:99]
  v_pk_mul_f32 v[102:103], v[72:73], v[98:99]
  v_pk_mul_f32 v[104:105], v[74:75], v[98:99]
  v_pk_mul_f32 v[106:107], v[76:77], v[98:99]
  v_pk_mul_f32 v[108:109], v[78:79], v[98:99]
  v_pk_mul_f32 v[110:111], v[80:81], v[98:99]
  v_pk_mul_f32 v[112:113], v[82:83], v[98:99]
  v_pk_mul_f32 v[114:115], v[84:85], v[98:99]
  v_pk_fma_f32 v[100:101], v[72:73], v[96:97], v[100:101]
  v_pk_fma_f32 v[102:103], v[74:75], v[96:97], v[102:103]
  v_pk_fma_f32 v[104:105], v[76:77], v[96:97], v[104:105]
  v_pk_fma_f32 v[106:107], v[78:79], v[96:97], v[106:107]
  v_pk_fma_f32 v[108:109], v[80:81], v[96:97], v[108:109]
  v_pk_fma_f32 v[110:111], v[82:83], v[96:97], v[110:111]
  v_pk_fma_f32 v[112:113], v[84:85], v[96:97], v[112:113]
  v_pk_fma_f32 v[114:115], v[86:87], v[96:97], v[114:115]
  v_pk_fma_f32 v[100:101], v[74:75], v[94:95], v[100:101]
  v_pk_fma_f32 v[102:103], v[76:77], v[94:95], v[102:103]
  v_pk_fma_f32 v[104:105], v[78:79], v[94:95], v[104:105]
  v_pk_fma_f32 v[106:107], v[80:81], v[94:95], v[106:107]
  v_pk_fma_f32 v[108:109], v[82:83], v[94:95], v[108:109]
  v_pk_fma_f32 v[110:111], v[84:85], v[94:95], v[110:111]
  v_pk_fma_f32 v[112:113], v[86:87], v[94:95], v[112:113]
  v_pk_fma_f32 v[114:115], v[88:89], v[94:95], v[114:115]
  v_pk_fma_f32 v[100:101], v[76:77], v[92:93], v[100:101]
  v_pk_fma_f32 v[102:103], v[78:79], v[92:93], v[102:103]
  v_pk_fma_f32 v[104:105], v[80:81], v[92:93], v[104:105]
  v_pk_fma_f32 v[106:107], v[82:83], v[92:93], v[106:107]
  v_pk_fma_f32 v[108:109], v[84:85], v[92:93], v[108:109]
  v_pk_fma_f32 v[110:111], v[86:87], v[92:93], v[110:111]
  v_pk_fma_f32 v[112:113], v[88:89], v[92:93], v[112:113]
  v_pk_fma_f32 v[114:115], v[90:91], v[92:93], v[114:115]
  s_waitcnt vmcnt(14)
  v_lshlrev_b32 v70, 16, v17
  v_and_b32 v71, s70, v17
  v_lshlrev_b32 v72, 16, v18
  v_and_b32 v73, s70, v18
  v_lshlrev_b32 v74, 16, v19
  v_and_b32 v75, s70, v19
  v_lshlrev_b32 v76, 16, v20
  v_and_b32 v77, s70, v20
  v_lshlrev_b32 v78, 16, v21
  v_and_b32 v79, s70, v21
  v_lshlrev_b32 v80, 16, v22
  v_and_b32 v81, s70, v22
  v_lshlrev_b32 v82, 16, v23
  v_and_b32 v83, s70, v23
  v_lshlrev_b32 v84, 16, v24
  v_and_b32 v85, s70, v24
  v_pk_mul_f32 v[100:101], v[100:101], v[70:71]
  v_pk_mul_f32 v[102:103], v[102:103], v[72:73]
  v_pk_mul_f32 v[104:105], v[104:105], v[74:75]
  v_pk_mul_f32 v[106:107], v[106:107], v[76:77]
  v_pk_mul_f32 v[108:109], v[108:109], v[78:79]
  v_pk_mul_f32 v[110:111], v[110:111], v[80:81]
  v_pk_mul_f32 v[112:113], v[112:113], v[82:83]
  v_pk_mul_f32 v[114:115], v[114:115], v[84:85]
  v_cvt_pk_bf16_f32 v92, v114, v112
  v_cvt_pk_bf16_f32 v93, v110, v108
  v_cvt_pk_bf16_f32 v94, v106, v104
  v_cvt_pk_bf16_f32 v95, v102, v100
  v_cvt_pk_bf16_f32 v96, v115, v113
  v_cvt_pk_bf16_f32 v97, v111, v109
  v_cvt_pk_bf16_f32 v98, v107, v105
  v_cvt_pk_bf16_f32 v99, v103, v101
  ds_bpermute_b32 v132, v238, v92
  ds_bpermute_b32 v133, v238, v93
  ds_bpermute_b32 v134, v238, v94
  ds_bpermute_b32 v135, v238, v95
  ds_bpermute_b32 v136, v238, v96
  ds_bpermute_b32 v137, v238, v97
  ds_bpermute_b32 v138, v238, v98
  ds_bpermute_b32 v139, v238, v99
  s_waitcnt lgkmcnt(4)
  buffer_store_dwordx4 v[132:135], v236, s[44:47], 0 offen
  s_waitcnt lgkmcnt(0)
  buffer_store_dwordx4 v[136:139], v236, s[44:47], s67 offen
  s_waitcnt vmcnt(14)
  v_dot2_f32_bf16 v6, v42, s71, 0
  v_dot2_f32_bf16 v7, v42, v42, 0
  v_dot2_f32_bf16 v8, v46, s71, 0
  v_dot2_f32_bf16 v9, v46, v46, 0
  v_dot2_f32_bf16 v6, v43, s71, v6
  v_dot2_f32_bf16 v7, v43, v43, v7
  v_dot2_f32_bf16 v8, v47, s71, v8
  v_dot2_f32_bf16 v9, v47, v47, v9
  v_dot2_f32_bf16 v6, v44, s71, v6
  v_dot2_f32_bf16 v7, v44, v44, v7
  v_dot2_f32_bf16 v8, v48, s71, v8
  v_dot2_f32_bf16 v9, v48, v48, v9
  v_dot2_f32_bf16 v6, v45, s71, v6
  v_dot2_f32_bf16 v7, v45, v45, v7
  v_dot2_f32_bf16 v8, v49, s71, v8
  v_dot2_f32_bf16 v9, v49, v49, v9
  s_nop 1
  v_permlane32_swap_b32 v6, v8
  v_permlane32_swap_b32 v7, v9
  v_add_f32 v6, v6, v8
  v_add_f32 v7, v7, v9
  s_nop 1
  v_permlane16_swap_b32 v6, v7
  v_add_f32 v6, v6, v7
  s_nop 1
  v_add_f32_dpp v6, v6, v6 row_ror:8 row_mask:0xf bank_mask:0xf
  s_nop 1
  v_add_f32_dpp v6, v6, v6 row_ror:4 row_mask:0xf bank_mask:0xf
  s_nop 1
  v_add_f32_dpp v6, v6, v6 row_ror:2 row_mask:0xf bank_mask:0xf
  s_nop 1
  v_add_f32_dpp v6, v6, v6 row_ror:1 row_mask:0xf bank_mask:0xf
  v_mov_b32 v7, v6
  s_nop 1
  v_permlane16_swap_b32 v6, v7
  v_mul_f32 v9, 0xbb000000, v6
  v_mul_f32 v7, 0x3b000000, v7
  v_fma_f32 v249, -v9, v9, v7
  v_max_f32 v249, 0, v249
  v_add_f32 v249, 0x3727c5ac, v249
  v_rsq_f32 v8, v249
  s_lshl_b32 s59, s2, 4
  s_lshl_b32 s60, s57, 12
  s_add_u32 s59, s59, s60
  s_add_u32 s59, s59, 688128
  v_cvt_pk_bf16_f32 v6, v9, v8
  v_mov_b32 v7, v253
  v_mov_b32 v8, v6
  v_mov_b32 v9, v253
  s_nop 0
  v_permlane32_swap_b32 v6, v8
  v_mov_b32 v249, 2147483648
  v_writelane_b32 v249, s59, 0
  buffer_store_dwordx4 v[6:9], v249, s[44:47], 0 offen sc1
  s_waitcnt vmcnt(11)
  v_lshlrev_b32 v50, 16, v50
  v_lshlrev_b32 v51, 16, v51
  v_lshlrev_b32 v52, 16, v52
  v_lshlrev_b32 v53, 16, v53
  v_mul_f32 v6, 0xbfb8aa3b, v50
  v_mul_f32 v7, 0xbfb8aa3b, v51
  v_mul_f32 v8, 0xbfb8aa3b, v52
  v_mul_f32 v9, 0xbfb8aa3b, v53
  v_exp_f32 v6, v6
  v_exp_f32 v7, v7
  v_exp_f32 v8, v8
  v_exp_f32 v9, v9
  v_add_f32 v6, 1.0, v6
  v_add_f32 v7, 1.0, v7
  v_add_f32 v8, 1.0, v8
  v_add_f32 v9, 1.0, v9
  v_rcp_f32 v6, v6
  v_rcp_f32 v7, v7
  v_rcp_f32 v8, v8
  v_rcp_f32 v9, v9
  v_mul_f32 v6, v6, v50
  v_mul_f32 v7, v7, v51
  v_mul_f32 v8, v8, v52
  v_mul_f32 v9, v9, v53
  v_cvt_pk_bf16_f32 v10, v6, v7
  v_cvt_pk_bf16_f32 v11, v8, v9
  v_and_b32 v249, 7, v255
  v_lshlrev_b32 v249, 7, v249
  v_lshrrev_b32 v248, 4, v255
  v_lshl_add_u32 v249, v248, 5, v249
  s_lshl_b32 s59, s57, 2
  v_add_u32 v249, s59, v249
  s_waitcnt vmcnt(9)
  v_perm_b32 v20, v58, v54, s68
  v_perm_b32 v21, v58, v54, s69
  v_perm_b32 v22, v59, v55, s68
  v_perm_b32 v23, v59, v55, s69
  v_perm_b32 v24, v60, v56, s68
  v_perm_b32 v25, v60, v56, s69
  v_perm_b32 v26, v61, v57, s68
  v_perm_b32 v27, v61, v57, s69
  v_dot2_f32_bf16 v12, v20, v10, 0
  v_dot2_f32_bf16 v13, v21, v10, 0
  v_dot2_f32_bf16 v14, v22, v10, 0
  v_dot2_f32_bf16 v15, v23, v10, 0
  v_dot2_f32_bf16 v16, v24, v10, 0
  v_dot2_f32_bf16 v17, v25, v10, 0
  v_dot2_f32_bf16 v18, v26, v10, 0
  v_dot2_f32_bf16 v19, v27, v10, 0
  s_waitcnt vmcnt(7)
  v_perm_b32 v20, v66, v62, s68
  v_perm_b32 v21, v66, v62, s69
  v_perm_b32 v22, v67, v63, s68
  v_perm_b32 v23, v67, v63, s69
  v_perm_b32 v24, v68, v64, s68
  v_perm_b32 v25, v68, v64, s69
  v_perm_b32 v26, v69, v65, s68
  v_perm_b32 v27, v69, v65, s69
  v_dot2_f32_bf16 v12, v20, v11, v12
  v_dot2_f32_bf16 v13, v21, v11, v13
  v_dot2_f32_bf16 v14, v22, v11, v14
  v_dot2_f32_bf16 v15, v23, v11, v15
  v_dot2_f32_bf16 v16, v24, v11, v16
  v_dot2_f32_bf16 v17, v25, v11, v17
  v_dot2_f32_bf16 v18, v26, v11, v18
  v_dot2_f32_bf16 v19, v27, v11, v19
  v_permlane32_swap_b32 v12, v16
  v_permlane32_swap_b32 v13, v17
  v_permlane32_swap_b32 v14, v18
  v_permlane32_swap_b32 v15, v19
  v_add_f32 v12, v12, v16
  v_add_f32 v13, v13, v17
  v_add_f32 v14, v14, v18
  v_add_f32 v15, v15, v19
  s_nop 0
  v_permlane16_swap_b32 v12, v14
  v_permlane16_swap_b32 v13, v15
  v_add_f32 v12, v12, v14
  v_add_f32 v13, v13, v15
  s_nop 0
  v_add_f32_dpp v12, v12, v12 row_ror:8 row_mask:0xf bank_mask:0xf
  v_add_f32_dpp v13, v13, v13 row_ror:8 row_mask:0xf bank_mask:0xf
  ds_write_b32 v249, v12 offset:9216
  ds_write_b32 v249, v13 offset:9232
  s_waitcnt vmcnt(1)
  s_mov_b32 s65, 8388608
  buffer_store_dword v235, v237, s[44:47], s65 offen
  s_waitcnt lgkmcnt(0)
  s_barrier
  ds_read_b128 v[6:9], v254 offset:9216
  s_waitcnt lgkmcnt(0)
  v_add_f32 v6, v6, v7
  v_add_f32 v8, v8, v9
  v_mov_b32 v7, v253
  v_add_f32 v6, v6, v8
  s_mov_b32 s60, 8323072
  buffer_store_dwordx2 v[6:7], v231, s[44:47], s60 offen
  v_add_u32 v247, 33280, v250
  ds_write_b128 v250, v[118:121] offset:27856
  ds_write_b128 v250, v[120:123] offset:44496
  v_alignbit_b32 v16, v117, v116, 16
  v_alignbit_b32 v17, v118, v117, 16
  v_alignbit_b32 v18, v119, v118, 16
  v_alignbit_b32 v19, v120, v119, 16
  v_alignbit_b32 v20, v121, v120, 16
  v_alignbit_b32 v21, v122, v121, 16
  ds_write_b128 v250, v[16:19] offset:15376
  ds_write_b128 v250, v[18:21] offset:32016
  s_mov_b32 s65, 8388608
  buffer_load_dword v232, v234, s[44:47], s65 offen sc1
  v_alignbit_b32 v22, v118, v117, 16
  v_alignbit_b32 v23, v119, v118, 16
  v_alignbit_b32 v24, v120, v119, 16
  v_alignbit_b32 v25, v121, v120, 16
  v_alignbit_b32 v26, v122, v121, 16
  v_alignbit_b32 v27, v123, v122, 16
  ds_write_b128 v250, v[22:25] offset:23696
  ds_write_b128 v250, v[24:27] offset:40336
  v_mov_b32 v10, v117
  v_mov_b32 v11, v118
  v_mov_b32 v12, v119
  v_mov_b32 v13, v120
  v_mov_b32 v14, v121
  v_mov_b32 v15, v122
  ds_write_b128 v250, v[10:13] offset:19536
  ds_write_b128 v250, v[12:15] offset:36176
  ds_write_b128 v247, v[126:129] offset:27856
  ds_write_b128 v247, v[128:131] offset:44496
  v_alignbit_b32 v16, v125, v124, 16
  v_alignbit_b32 v17, v126, v125, 16
  v_alignbit_b32 v18, v127, v126, 16
  v_alignbit_b32 v19, v128, v127, 16
  v_alignbit_b32 v20, v129, v128, 16
  v_alignbit_b32 v21, v130, v129, 16
  ds_write_b128 v247, v[16:19] offset:15376
  ds_write_b128 v247, v[18:21] offset:32016
  s_waitcnt vmcnt(0)
  v_cmp_ne_u32 vcc, v232, v235
  s_nop 4
  s_cbranch_vccz lok_2
lslow_1:
  s_mov_b32 s73, 0
lagain_4:
  s_add_u32 s58, s58, 1
  s_cmp_gt_u32 s58, 200000
  s_cbranch_scc1 lok_2
  s_mov_b32 s65, 8388608
  buffer_load_dword v232, v234, s[44:47], s65 offen sc1
  s_waitcnt vmcnt(0)
  v_cmp_ne_u32 vcc, v232, v235
  s_nop 4
  s_cbranch_vccz lok_2
  s_cmp_ge_u32 s73, 0x10000
  s_cbranch_scc1 lnorel_5
  s_add_u32 s73, s73, 1
  s_cmp_ge_u32 s73, 40
  s_cbranch_scc1 lrel_3
  v_cmp_eq_u32 vcc, v232, v253
  s_nop 4
  s_cbranch_vccz lagain_4
lrel_3:
  buffer_wbl2 sc1
  s_waitcnt vmcnt(0)
  s_mov_b32 s65, 8388608
  buffer_store_dword v253, v237, s[44:47], s65 offen sc1
  s_mov_b32 s73, 0x10000
lnorel_5:
  v_cmp_ne_u32 vcc, v232, v235
  v_cmp_ne_u32 s[54:55], v232, v253
  s_nop 3
  s_and_b64 s[54:55], vcc, s[54:55]
  s_cbranch_scc1 lagain_4
  s_waitcnt vmcnt(0)
  s_branch lok_2
lok_2:
  s_lshl_b32 s84, s72, 12
  s_add_u32 s84, s84, 1048576
  s_add_u32 s85, s84, 4096
  buffer_load_dwordx4 v[42:45], v250, s[44:47], s84 offen sc1
  buffer_load_dwordx4 v[46:49], v250, s[44:47], s85 offen sc1
  s_mov_b32 s65, 8323072
  buffer_load_dwordx4 v[30:33], v233, s[44:47], s65 offen sc1
  s_add_u32 s65, s65, 32768
  buffer_load_dwordx4 v[34:37], v233, s[44:47], s65 offen sc1
  s_add_u32 s65, s65, 32768
  buffer_load_dwordx4 v[38:41], v233, s[44:47], s65 offen sc1
  v_alignbit_b32 v22, v126, v125, 16
  v_alignbit_b32 v23, v127, v126, 16
  v_alignbit_b32 v24, v128, v127, 16
  v_alignbit_b32 v25, v129, v128, 16
  v_alignbit_b32 v26, v130, v129, 16
  v_alignbit_b32 v27, v131, v130, 16
  ds_write_b128 v247, v[22:25] offset:23696
  ds_write_b128 v247, v[24:27] offset:40336
  v_mov_b32 v10, v125
  v_mov_b32 v11, v126
  v_mov_b32 v12, v127
  v_mov_b32 v13, v128
  v_mov_b32 v14, v129
  v_mov_b32 v15, v130
  ds_write_b128 v247, v[10:13] offset:19536
  ds_write_b128 v247, v[12:15] offset:36176
  buffer_store_dwordx2 v[6:7], v231, s[44:47], 0 offen sc1
  s_mul_i32 s52, s81, 57344
  s_mul_i32 s60, s82, 224
  s_add_u32 s52, s52, s60
  v_mul_u32_u24 v231, 28672, v252
  v_lshl_add_u32 v231, v251, 3, v231
  buffer_load_dwordx2 v[6:7], v231, s[24:27], s52 offen offset:0 nt
  buffer_load_dwordx2 v[8:9], v231, s[24:27], s52 offen offset:3584 nt
  s_add_u32 s52, s52, 7168
  buffer_load_dwordx2 v[10:11], v231, s[24:27], s52 offen offset:0 nt
  buffer_load_dwordx2 v[12:13], v231, s[24:27], s52 offen offset:3584 nt
  s_add_u32 s52, s52, 7168
  buffer_load_dwordx2 v[14:15], v231, s[24:27], s52 offen offset:0 nt
  buffer_load_dwordx2 v[16:17], v231, s[24:27], s52 offen offset:3584 nt
  s_add_u32 s52, s52, 7168
  buffer_load_dwordx2 v[18:19], v231, s[24:27], s52 offen offset:0 nt
  buffer_load_dwordx2 v[20:21], v231, s[24:27], s52 offen offset:3584 nt
  s_mul_i32 s59, s2, 7168
  s_add_u32 s60, s59, 3072
  buffer_load_dwordx4 v[2:5], v250, s[28:31], s59 offen
  buffer_load_dwordx4 v[2:5], v250, s[28:31], s60 offen
  s_lshl_b32 s59, s86, 16
  v_mov_b32 v249, 2147483648
  v_writelane_b32 v249, s59, 0
  buffer_load_dword v232, v249, s[40:43], 0 offen
  s_mov_b32 s65, 65536
  buffer_load_dword v232, v219, s[44:47], s65 offen sc1
  s_mov_b32 s65, 262144
  buffer_load_dword v232, v218, s[44:47], s65 offen sc1
  s_lshl_b32 s59, s92, 2
  s_add_u32 s59, s59, s57
  s_lshl_b32 s59, s59, 4
  s_add_u32 s59, s59, s93
  s_lshl_b32 s59, s59, 5
  v_min_u32 v249, 3, v255
  v_lshl_add_u32 v249, v249, 15, s59
  s_mov_b32 s65, 393216
  buffer_load_dword v232, v249, s[44:47], s65 offen sc1
  v_sub_u32 v247, 4080, v250
  s_waitcnt vmcnt(19)
  ds_write_b128 v247, v[42:45] offset:0
  s_waitcnt vmcnt(18)
  ds_write_b128 v247, v[46:49] offset:4608
  s_waitcnt lgkmcnt(0)
  s_barrier
  ds_read_b128 a[224:227], v230 offset:15360
  ds_read_b128 a[160:163], v229 offset:3584
  ds_read_b128 a[228:231], v230 offset:15872
  ds_read_b128 a[164:167], v229 offset:3072
  ds_read_b128 a[232:235], v230 offset:16384
  ds_read_b128 a[168:171], v229 offset:2560
  ds_read_b128 a[236:239], v230 offset:16896
  ds_read_b128 a[172:175], v229 offset:2048
  ds_read_b128 a[240:243], v230 offset:17408
  ds_read_b128 a[176:179], v229 offset:1536
  ds_read_b128 a[244:247], v230 offset:17920
  ds_read_b128 a[180:183], v229 offset:1024
  ds_read_b128 a[248:251], v230 offset:18432
  ds_read_b128 a[184:187], v229 offset:512
  ds_read_b128 a[252:255], v230 offset:18944
  ds_read_b128 a[188:191], v229 offset:0
  s_waitcnt lgkmcnt(14)
  v_mfma_f32_16x16x32_bf16 v[22:25], a[224:227], a[160:163], 0
  s_waitcnt lgkmcnt(12)
  v_mfma_f32_16x16x32_bf16 v[26:29], a[224:227], a[164:167], 0
  ds_read_b128 a[192:195], v230 offset:15424
  v_mfma_f32_16x16x32_bf16 v[26:29], a[228:231], a[160:163], v[26:29]
  v_mfma_f32_16x16x32_bf16 v[42:45], a[228:231], a[164:167], 0
  ds_read_b128 v[66:69], v229 offset:3648
  s_waitcnt lgkmcnt(12)
  v_mfma_f32_16x16x32_bf16 v[42:45], a[224:227], a[168:171], v[42:45]
  v_mfma_f32_16x16x32_bf16 v[46:49], a[228:231], a[168:171], 0
  ds_read_b128 a[196:199], v230 offset:15936
  v_mfma_f32_16x16x32_bf16 v[42:45], a[232:235], a[160:163], v[42:45]
  v_mfma_f32_16x16x32_bf16 v[46:49], a[232:235], a[164:167], v[46:49]
  ds_read_b128 v[70:73], v229 offset:3136
  v_mfma_f32_16x16x32_bf16 v[50:53], a[232:235], a[168:171], 0
  s_waitcnt lgkmcnt(12)
  v_mfma_f32_16x16x32_bf16 v[46:49], a[224:227], a[172:175], v[46:49]
  ds_read_b128 a[200:203], v230 offset:16448
  v_mfma_f32_16x16x32_bf16 v[50:53], a[228:231], a[172:175], v[50:53]
  v_mfma_f32_16x16x32_bf16 v[54:57], a[232:235], a[172:175], 0
  ds_read_b128 v[74:77], v229 offset:2624
  v_mfma_f32_16x16x32_bf16 v[46:49], a[236:239], a[160:163], v[46:49]
  s_waitcnt vmcnt(15)
chk_6:
  v_min3_u32 v231, v253, v31, v33
  v_max3_u32 v216, v253, v31, v33
  v_min3_u32 v231, v231, v35, v37
  v_max3_u32 v216, v216, v35, v37
  v_min3_u32 v231, v231, v39, v41
  v_max3_u32 v216, v216, v39, v41
  v_cmp_ne_u32 vcc, v231, v216
  s_nop 4
  s_cbranch_vccz ok_8
slow_7:
  s_add_u32 s58, s58, 1
  s_cmp_gt_u32 s58, 200000
  s_cbranch_scc1 ok_8
  s_and_b32 s65, s58, 7
  s_cmp_eq_u32 s65, 0
  s_cselect_b32 s65, 0, 8323072
  buffer_load_dwordx4 v[30:33], v233, s[44:47], s65 offen sc1
  s_add_u32 s65, s65, 32768
  buffer_load_dwordx4 v[34:37], v233, s[44:47], s65 offen sc1
  s_add_u32 s65, s65, 32768
  buffer_load_dwordx4 v[38:41], v233, s[44:47], s65 offen sc1
  s_waitcnt vmcnt(0)
  s_branch chk_6
ok_8:
  v_permlane16_swap_b32 v38, v40
  v_permlane16_swap_b32 v34, v36
  v_mfma_f32_16x16x32_bf16 v[50:53], a[236:239], a[164:167], v[50:53]
  ds_read_b128 a[204:207], v230 offset:16960
  v_permlane16_swap_b32 v30, v32
  v_mfma_f32_16x16x32_bf16 v[54:57], a[236:239], a[168:171], v[54:57]
  v_add_f32 v38, v38, v40
  v_add_f32 v34, v34, v36
  v_mfma_f32_16x16x32_bf16 v[58:61], a[236:239], a[172:175], 0
  ds_read_b128 v[78:81], v229 offset:2112
  v_add_f32 v30, v30, v32
  s_waitcnt lgkmcnt(14)
  v_mfma_f32_16x16x32_bf16 v[50:53], a[224:227], a[176:179], v[50:53]
  s_add_u32 m0, s89, 12288
  s_add_u32 s83, s88, 0
  buffer_load_dwordx4 v246, s[28:31], s83 offen lds
  v_add_f32_dpp v38, v38, v38 row_ror:8 row_mask:0xf bank_mask:0xf
  v_add_f32_dpp v34, v34, v34 row_ror:8 row_mask:0xf bank_mask:0xf
  v_mfma_f32_16x16x32_bf16 v[54:57], a[228:231], a[176:179], v[54:57]
  ds_read_b128 a[208:211], v230 offset:17472
  v_add_f32_dpp v30, v30, v30 row_ror:8 row_mask:0xf bank_mask:0xf
  v_mfma_f32_16x16x32_bf16 v[58:61], a[232:235], a[176:179], v[58:61]
  v_and_b32 v31, 7, v255
  v_lshlrev_b32 v31, 3, v31
  v_mfma_f32_16x16x32_bf16 v[62:65], a[236:239], a[176:179], 0
  ds_read_b128 v[82:85], v229 offset:1600
  v_bfe_u32 v33, v255, 4, 1
  v_mfma_f32_16x16x32_bf16 v[50:53], a[240:243], a[160:163], v[50:53]
  s_add_u32 m0, s89, 12288
  s_nop 0
  buffer_load_dwordx4 v245, s[28:31], s83 offen offset:1024 lds
  v_lshl_add_u32 v31, v33, 2, v31
  v_lshl_add_u32 v31, v252, 6, v31
  v_mfma_f32_16x16x32_bf16 v[54:57], a[240:243], a[164:167], v[54:57]
  ds_read_b128 a[212:215], v230 offset:17984
  v_add_u32 v31, s89, v31
  v_mfma_f32_16x16x32_bf16 v[58:61], a[240:243], a[168:171], v[58:61]
  v_cvt_f32_u32 v33, v252
  v_cvt_pk_bf16_f32 v38, v38, v38
  v_mfma_f32_16x16x32_bf16 v[62:65], a[240:243], a[172:175], v[62:65]
  ds_read_b128 v[86:89], v229 offset:1088
  v_cvt_pk_bf16_f32 v34, v34, v34
  s_waitcnt lgkmcnt(15)
  v_mfma_f32_16x16x32_bf16 v[54:57], a[224:227], a[180:183], v[54:57]
  s_add_u32 m0, s89, 14336
  s_add_u32 s83, s88, 16384
  buffer_load_dwordx4 v246, s[28:31], s83 offen lds
  v_cvt_pk_bf16_f32 v30, v30, v30
  v_sub_f32 v35, 1.0, v33
  v_mfma_f32_16x16x32_bf16 v[58:61], a[228:231], a[180:183], v[58:61]
  ds_read_b128 a[216:219], v230 offset:18496
  v_and_b32 v38, s70, v38
  v_mfma_f32_16x16x32_bf16 v[62:65], a[232:235], a[180:183], v[62:65]
  v_and_b32 v34, s70, v34
  v_and_b32 v30, s70, v30
  v_mfma_f32_16x16x32_bf16 v[54:57], a[244:247], a[160:163], v[54:57]
  ds_read_b128 v[90:93], v229 offset:576
  v_add_f32 v38, v38, v35
  v_mfma_f32_16x16x32_bf16 v[58:61], a[244:247], a[164:167], v[58:61]
  s_add_u32 m0, s89, 14336
  s_nop 0
  buffer_load_dwordx4 v245, s[28:31], s83 offen offset:1024 lds
  v_add_f32 v30, v30, v33
  v_cvt_pk_bf16_f32 v38, v38, v38
  v_mfma_f32_16x16x32_bf16 v[62:65], a[244:247], a[168:171], v[62:65]
  ds_read_b128 a[220:223], v230 offset:19008
  v_cvt_pk_bf16_f32 v30, v30, v30
  s_waitcnt lgkmcnt(15)
  v_mfma_f32_16x16x32_bf16 v[58:61], a[224:227], a[184:187], v[58:61]
  v_and_b32 v38, s70, v38
  v_and_b32 v30, s70, v30
  v_mfma_f32_16x16x32_bf16 v[62:65], a[228:231], a[184:187], v[62:65]
  ds_read_b128 v[94:97], v229 offset:64
  ds_write_b32 v31, v38 offset:11520
  v_mfma_f32_16x16x32_bf16 v[58:61], a[248:251], a[160:163], v[58:61]
  s_add_u32 m0, s89, 16384
  s_add_u32 s83, s88, 32768
  buffer_load_dwordx4 v246, s[28:31], s83 offen lds
  ds_write_b32 v31, v34 offset:11392
  ds_write_b32 v31, v30 offset:11264
  v_mfma_f32_16x16x32_bf16 v[62:65], a[248:251], a[164:167], v[62:65]
  v_mfma_f32_16x16x32_bf16 v[62:65], a[224:227], a[188:191], v[62:65]
  v_lshlrev_b32 v249, 5, v252
  v_add_u32 v249, s89, v249
  ds_read_b128 v[38:41], v249 offset:11520
  ds_read_b128 v[98:101], v249 offset:11536
  ds_read_b128 v[30:33], v249 offset:11456
  ds_read_b128 v[34:37], v249 offset:11472
  v_mfma_f32_16x16x32_bf16 v[62:65], a[252:255], a[160:163], v[62:65]
  s_waitcnt lgkmcnt(7)
  v_mfma_f32_16x16x32_bf16 v[22:25], a[192:195], v[66:69], v[22:25]
  s_add_u32 m0, s89, 16384
  s_nop 0
  buffer_load_dwordx4 v245, s[28:31], s83 offen offset:1024 lds
  s_waitcnt vmcnt(12)
  v_mfma_f32_16x16x32_bf16 v[26:29], a[192:195], v[70:73], v[26:29]
  ds_read_b128 a[224:227], v230 offset:15488
  v_lshlrev_b32 v102, 16, v6
  v_mfma_f32_16x16x32_bf16 v[26:29], a[196:199], v[66:69], v[26:29]
  v_and_b32 v103, s70, v6
  v_lshlrev_b32 v104, 16, v7
  v_mfma_f32_16x16x32_bf16 v[42:45], a[196:199], v[70:73], v[42:45]
  ds_read_b128 a[160:163], v229 offset:3712
  v_and_b32 v105, s70, v7
  v_mfma_f32_16x16x32_bf16 v[42:45], a[192:195], v[74:77], v[42:45]
  s_add_u32 m0, s89, 18432
  s_add_u32 s83, s88, 114688
  buffer_load_dwordx4 v246, s[28:31], s83 offen lds
  v_lshlrev_b32 v106, 16, v8
  v_and_b32 v107, s70, v8
  v_mfma_f32_16x16x32_bf16 v[46:49], a[196:199], v[74:77], v[46:49]
  ds_read_b128 a[228:231], v230 offset:16000
  v_lshlrev_b32 v108, 16, v9
  v_mfma_f32_16x16x32_bf16 v[42:45], a[200:203], v[66:69], v[42:45]
  v_and_b32 v109, s70, v9
  v_lshlrev_b32 v110, 16, v10
  v_mfma_f32_16x16x32_bf16 v[46:49], a[200:203], v[70:73], v[46:49]
  ds_read_b128 a[164:167], v229 offset:3200
  v_and_b32 v111, s70, v10
  v_mfma_f32_16x16x32_bf16 v[50:53], a[200:203], v[74:77], v[50:53]
  s_add_u32 m0, s89, 18432
  s_nop 0
  buffer_load_dwordx4 v245, s[28:31], s83 offen offset:1024 lds
  v_lshlrev_b32 v112, 16, v11
  v_and_b32 v113, s70, v11
  v_mfma_f32_16x16x32_bf16 v[46:49], a[192:195], v[78:81], v[46:49]
  ds_read_b128 a[232:235], v230 offset:16512
  v_lshlrev_b32 v114, 16, v12
  v_mfma_f32_16x16x32_bf16 v[50:53], a[196:199], v[78:81], v[50:53]
  v_and_b32 v115, s70, v12
  v_lshlrev_b32 v116, 16, v13
  v_mfma_f32_16x16x32_bf16 v[54:57], a[200:203], v[78:81], v[54:57]
  ds_read_b128 a[168:171], v229 offset:2688
  v_and_b32 v117, s70, v13
  v_mfma_f32_16x16x32_bf16 v[46:49], a[204:207], v[66:69], v[46:49]
  s_add_u32 m0, s89, 0
  s_add_u32 s83, s88, 131072
  buffer_load_dwordx4 v246, s[28:31], s83 offen lds
  v_lshlrev_b32 v118, 16, v14
  v_and_b32 v119, s70, v14
  v_mfma_f32_16x16x32_bf16 v[50:53], a[204:207], v[70:73], v[50:53]
  ds_read_b128 a[236:239], v230 offset:17024
  v_lshlrev_b32 v120, 16, v15
  v_mfma_f32_16x16x32_bf16 v[54:57], a[204:207], v[74:77], v[54:57]
  buffer_load_dword v144, v239, s[4:7], 0 offen offset:0
  v_and_b32 v121, s70, v15
  v_lshlrev_b32 v122, 16, v16
  v_mfma_f32_16x16x32_bf16 v[58:61], a[204:207], v[78:81], v[58:61]
  ds_read_b128 a[172:175], v229 offset:2176
  v_and_b32 v123, s70, v16
  v_mfma_f32_16x16x32_bf16 v[50:53], a[192:195], v[82:85], v[50:53]
  buffer_load_dword v145, v239, s[4:7], 0 offen offset:1024
  s_add_u32 m0, s89, 0
  s_nop 0
  buffer_load_dwordx4 v245, s[28:31], s83 offen offset:1024 lds
  v_lshlrev_b32 v124, 16, v17
  v_and_b32 v125, s70, v17
  v_mfma_f32_16x16x32_bf16 v[54:57], a[196:199], v[82:85], v[54:57]
  ds_read_b128 a[240:243], v230 offset:17536
  v_lshlrev_b32 v126, 16, v18
  v_mfma_f32_16x16x32_bf16 v[58:61], a[200:203], v[82:85], v[58:61]
  buffer_load_dword v146, v239, s[4:7], 0 offen offset:2048
  v_and_b32 v127, s70, v18
  v_lshlrev_b32 v128, 16, v19
  v_mfma_f32_16x16x32_bf16 v[62:65], a[204:207], v[82:85], v[62:65]
  ds_read_b128 a[176:179], v229 offset:1664
  v_and_b32 v129, s70, v19
  v_mfma_f32_16x16x32_bf16 v[50:53], a[208:211], v[66:69], v[50:53]
  buffer_load_dword v147, v239, s[4:7], 0 offen offset:3072
  s_add_u32 m0, s89, 2048
  s_add_u32 s83, s88, 147456
  buffer_load_dwordx4 v246, s[28:31], s83 offen lds
  v_lshlrev_b32 v140, 16, v20
  v_and_b32 v141, s70, v20
  v_mfma_f32_16x16x32_bf16 v[54:57], a[208:211], v[70:73], v[54:57]
  ds_read_b128 a[244:247], v230 offset:18048
  v_lshlrev_b32 v142, 16, v21
  v_mfma_f32_16x16x32_bf16 v[58:61], a[208:211], v[74:77], v[58:61]
  buffer_load_dword v148, v239, s[4:7], s67 offen offset:0
  v_and_b32 v143, s70, v21
  s_waitcnt lgkmcnt(11)
  v_mfma_f32_16x16x32_bf16 v[62:65], a[208:211], v[78:81], v[62:65]
  ds_read_b128 a[180:183], v229 offset:1152
  v_mul_f32 v152, v102, v38
  v_mfma_f32_16x16x32_bf16 v[54:57], a[192:195], v[86:89], v[54:57]
  buffer_load_dword v149, v239, s[4:7], s67 offen offset:1024
  s_add_u32 m0, s89, 2048
  s_nop 0
  buffer_load_dwordx4 v245, s[28:31], s83 offen offset:1024 lds
  v_mul_f32 v153, v106, v39
  v_cvt_pk_bf16_f32 v6, v152, v153
  v_mfma_f32_16x16x32_bf16 v[58:61], a[196:199], v[86:89], v[58:61]
  ds_read_b128 a[248:251], v230 offset:18560
  v_mul_f32 v154, v110, v40
  v_mfma_f32_16x16x32_bf16 v[62:65], a[200:203], v[86:89], v[62:65]
  buffer_load_dword v150, v239, s[4:7], s67 offen offset:2048
  v_mul_f32 v155, v114, v41
  v_cvt_pk_bf16_f32 v7, v154, v155
  v_mfma_f32_16x16x32_bf16 v[54:57], a[212:215], v[66:69], v[54:57]
  ds_read_b128 a[184:187], v229 offset:640
  v_mul_f32 v152, v118, v98
  v_mfma_f32_16x16x32_bf16 v[58:61], a[212:215], v[70:73], v[58:61]
  buffer_load_dword v151, v239, s[4:7], s67 offen offset:3072
  v_mul_f32 v153, v122, v99
  v_cvt_pk_bf16_f32 v8, v152, v153
  v_mfma_f32_16x16x32_bf16 v[62:65], a[212:215], v[74:77], v[62:65]
  ds_read_b128 a[252:255], v230 offset:19072
  v_mul_f32 v154, v126, v100
  v_mfma_f32_16x16x32_bf16 v[58:61], a[192:195], v[90:93], v[58:61]
  v_mul_f32 v155, v140, v101
  v_cvt_pk_bf16_f32 v9, v154, v155
  v_mfma_f32_16x16x32_bf16 v[62:65], a[196:199], v[90:93], v[62:65]
  ds_read_b128 a[188:191], v229 offset:128
  buffer_store_dwordx4 v[6:9], v227, s[44:47], s53 offen offset:0 sc1
  v_mfma_f32_16x16x32_bf16 v[58:61], a[216:219], v[66:69], v[58:61]
  s_lshl_b32 s59, s81, 5
  v_lshrrev_b32 v249, 3, v255
  v_lshlrev_b32 v249, 2, v249
  buffer_load_dword v130, v249, s[48:51], s59 offen
  v_mul_f32 v152, v103, v38
  v_mul_f32 v153, v107, v39
  v_mfma_f32_16x16x32_bf16 v[62:65], a[216:219], v[70:73], v[62:65]
  v_cvt_pk_bf16_f32 v10, v152, v153
  v_mfma_f32_16x16x32_bf16 v[62:65], a[192:195], v[94:97], v[62:65]
  v_mul_f32 v154, v111, v40
  v_mul_f32 v155, v115, v41
  v_mfma_f32_16x16x32_bf16 v[62:65], a[220:223], v[66:69], v[62:65]
  v_cvt_pk_bf16_f32 v11, v154, v155
  s_waitcnt lgkmcnt(0)
  v_mfma_f32_16x16x32_bf16 v[22:25], a[224:227], a[160:163], v[22:25]
  v_mul_f32 v152, v119, v98
  v_mul_f32 v153, v123, v99
  v_mfma_f32_16x16x32_bf16 v[26:29], a[224:227], a[164:167], v[26:29]
  ds_read_b128 a[192:195], v230 offset:15552
  v_cvt_pk_bf16_f32 v12, v152, v153
  v_mfma_f32_16x16x32_bf16 v[26:29], a[228:231], a[160:163], v[26:29]
  v_mul_f32 v154, v127, v100
  v_mul_f32 v155, v141, v101
  v_mfma_f32_16x16x32_bf16 v[42:45], a[228:231], a[164:167], v[42:45]
  ds_read_b128 v[66:69], v229 offset:3776
  v_cvt_pk_bf16_f32 v13, v154, v155
  v_mfma_f32_16x16x32_bf16 v[42:45], a[224:227], a[168:171], v[42:45]
  buffer_store_dwordx4 v[10:13], v227, s[44:47], s53 offen offset:128 sc1
  v_mul_f32 v152, v104, v38
  v_mfma_f32_16x16x32_bf16 v[46:49], a[228:231], a[168:171], v[46:49]
  ds_read_b128 a[196:199], v230 offset:16064
  v_mul_f32 v153, v108, v39
  v_mfma_f32_16x16x32_bf16 v[42:45], a[232:235], a[160:163], v[42:45]
  v_cvt_pk_bf16_f32 v14, v152, v153
  v_mul_f32 v154, v112, v40
  v_mfma_f32_16x16x32_bf16 v[46:49], a[232:235], a[164:167], v[46:49]
  ds_read_b128 v[70:73], v229 offset:3264
  v_mul_f32 v155, v116, v41
  v_mfma_f32_16x16x32_bf16 v[50:53], a[232:235], a[168:171], v[50:53]
  v_cvt_pk_bf16_f32 v15, v154, v155
  v_mul_f32 v152, v120, v98
  v_mfma_f32_16x16x32_bf16 v[46:49], a[224:227], a[172:175], v[46:49]
  ds_read_b128 a[200:203], v230 offset:16576
  v_mul_f32 v153, v124, v99
  v_mfma_f32_16x16x32_bf16 v[50:53], a[228:231], a[172:175], v[50:53]
  s_waitcnt vmcnt(21)
  ds_read_b64_tr_b16 a[0:1], v244 offset:12288
  ds_read_b64_tr_b16 a[2:3], v244 offset:13312
  ds_read_b64_tr_b16 a[4:5], v243 offset:12288
  ds_read_b64_tr_b16 a[6:7], v243 offset:13312
  v_cvt_pk_bf16_f32 v16, v152, v153
  v_mul_f32 v154, v128, v100
  v_mfma_f32_16x16x32_bf16 v[54:57], a[232:235], a[172:175], v[54:57]
  ds_read_b128 v[74:77], v229 offset:2752
  v_mul_f32 v155, v142, v101
  v_mfma_f32_16x16x32_bf16 v[46:49], a[236:239], a[160:163], v[46:49]
  v_cvt_pk_bf16_f32 v17, v154, v155
  buffer_store_dwordx4 v[14:17], v227, s[44:47], s53 offen offset:256 sc1
  v_mfma_f32_16x16x32_bf16 v[50:53], a[236:239], a[164:167], v[50:53]
  ds_read_b128 a[204:207], v230 offset:17088
  v_mul_f32 v152, v105, v38
  v_mfma_f32_16x16x32_bf16 v[54:57], a[236:239], a[168:171], v[54:57]
  v_mul_f32 v153, v109, v39
  v_cvt_pk_bf16_f32 v18, v152, v153
  v_mfma_f32_16x16x32_bf16 v[58:61], a[236:239], a[172:175], v[58:61]
  ds_read_b128 v[78:81], v229 offset:2240
  v_mul_f32 v154, v113, v40
  v_mfma_f32_16x16x32_bf16 v[50:53], a[224:227], a[176:179], v[50:53]
  v_mul_f32 v155, v117, v41
  v_cvt_pk_bf16_f32 v19, v154, v155
  v_mfma_f32_16x16x32_bf16 v[54:57], a[228:231], a[176:179], v[54:57]
  ds_read_b128 a[208:211], v230 offset:17600
  v_mul_f32 v152, v121, v98
  v_mfma_f32_16x16x32_bf16 v[58:61], a[232:235], a[176:179], v[58:61]
  s_waitcnt vmcnt(20)
  ds_read_b64_tr_b16 a[8:9], v244 offset:14336
  ds_read_b64_tr_b16 a[10:11], v244 offset:15360
  ds_read_b64_tr_b16 a[12:13], v243 offset:14336
  ds_read_b64_tr_b16 a[14:15], v243 offset:15360
  v_mul_f32 v153, v125, v99
  v_cvt_pk_bf16_f32 v20, v152, v153
  v_mfma_f32_16x16x32_bf16 v[62:65], a[236:239], a[176:179], v[62:65]
  ds_read_b128 v[82:85], v229 offset:1728
  v_mul_f32 v154, v129, v100
  v_mfma_f32_16x16x32_bf16 v[50:53], a[240:243], a[160:163], v[50:53]
  v_mul_f32 v155, v143, v101
  v_cvt_pk_bf16_f32 v21, v154, v155
  v_mfma_f32_16x16x32_bf16 v[54:57], a[240:243], a[164:167], v[54:57]
  ds_read_b128 a[212:215], v230 offset:18112
  buffer_store_dwordx4 v[18:21], v227, s[44:47], s53 offen offset:384 sc1
  v_mfma_f32_16x16x32_bf16 v[58:61], a[240:243], a[168:171], v[58:61]
  v_mul_f32 v156, v102, v38
  v_mul_f32 v157, v103, v38
  v_mfma_f32_16x16x32_bf16 v[62:65], a[240:243], a[172:175], v[62:65]
  ds_read_b128 v[86:89], v229 offset:1216
  v_mul_f32 v158, v104, v38
  v_mfma_f32_16x16x32_bf16 v[54:57], a[224:227], a[180:183], v[54:57]
  v_mul_f32 v159, v105, v38
  v_mul_f32 v160, v102, v30
  v_mfma_f32_16x16x32_bf16 v[58:61], a[228:231], a[180:183], v[58:61]
  ds_read_b128 a[216:219], v230 offset:18624
  v_mul_f32 v161, v103, v30
  v_mfma_f32_16x16x32_bf16 v[62:65], a[232:235], a[180:183], v[62:65]
  s_waitcnt vmcnt(19)
  ds_read_b64_tr_b16 a[16:17], v244 offset:16384
  ds_read_b64_tr_b16 a[18:19], v244 offset:17408
  ds_read_b64_tr_b16 a[20:21], v243 offset:16384
  ds_read_b64_tr_b16 a[22:23], v243 offset:17408
  v_mul_f32 v162, v104, v30
  v_mul_f32 v163, v105, v30
  v_mfma_f32_16x16x32_bf16 v[54:57], a[244:247], a[160:163], v[54:57]
  ds_read_b128 v[90:93], v229 offset:704
  v_fmac_f32 v156, v106, v39
  v_mfma_f32_16x16x32_bf16 v[58:61], a[244:247], a[164:167], v[58:61]
  v_fmac_f32 v157, v107, v39
  v_fmac_f32 v158, v108, v39
  v_mfma_f32_16x16x32_bf16 v[62:65], a[244:247], a[168:171], v[62:65]
  ds_read_b128 a[220:223], v230 offset:19136
  v_fmac_f32 v159, v109, v39
  v_mfma_f32_16x16x32_bf16 v[58:61], a[224:227], a[184:187], v[58:61]
  v_fmac_f32 v160, v106, v31
  v_fmac_f32 v161, v107, v31
  v_mfma_f32_16x16x32_bf16 v[62:65], a[228:231], a[184:187], v[62:65]
  ds_read_b128 v[94:97], v229 offset:192
  v_fmac_f32 v162, v108, v31
  v_mfma_f32_16x16x32_bf16 v[58:61], a[248:251], a[160:163], v[58:61]
  v_fmac_f32 v163, v109, v31
  v_fmac_f32 v156, v110, v40
  v_mfma_f32_16x16x32_bf16 v[62:65], a[248:251], a[164:167], v[62:65]
  v_fmac_f32 v157, v111, v40
  v_mfma_f32_16x16x32_bf16 v[62:65], a[224:227], a[188:191], v[62:65]
  s_waitcnt vmcnt(17)
  ds_read_b64_tr_b16 a[24:25], v244 offset:18432
  ds_read_b64_tr_b16 a[26:27], v244 offset:19456
  ds_read_b64_tr_b16 a[28:29], v243 offset:18432
  ds_read_b64_tr_b16 a[30:31], v243 offset:19456
  v_fmac_f32 v158, v112, v40
  v_fmac_f32 v159, v113, v40
  v_mfma_f32_16x16x32_bf16 v[62:65], a[252:255], a[160:163], v[62:65]
  v_fmac_f32 v160, v110, v32
  s_waitcnt lgkmcnt(4)
  v_mfma_f32_16x16x32_bf16 v[22:25], a[192:195], v[66:69], v[22:25]
  v_fmac_f32 v161, v111, v32
  v_fmac_f32 v162, v112, v32
  v_mfma_f32_16x16x32_bf16 v[26:29], a[192:195], v[70:73], v[26:29]
  v_fmac_f32 v163, v113, v32
  v_fmac_f32 v156, v114, v41
  v_mfma_f32_16x16x32_bf16 v[26:29], a[196:199], v[66:69], v[26:29]
  v_fmac_f32 v157, v115, v41
  v_fmac_f32 v158, v116, v41
  v_mfma_f32_16x16x32_bf16 v[42:45], a[192:195], v[74:77], v[42:45]
  v_fmac_f32 v159, v117, v41
  v_fmac_f32 v160, v114, v33
  v_mfma_f32_16x16x32_bf16 v[42:45], a[196:199], v[70:73], v[42:45]
  v_fmac_f32 v161, v115, v33
  v_fmac_f32 v162, v116, v33
  v_mfma_f32_16x16x32_bf16 v[42:45], a[200:203], v[66:69], v[42:45]
  ds_write_b128 v228, v[22:25] offset:0
  v_fmac_f32 v163, v117, v33
  v_fmac_f32 v156, v118, v98
  v_mfma_f32_16x16x32_bf16 v[46:49], a[192:195], v[78:81], v[46:49]
  v_fmac_f32 v157, v119, v98
  v_fmac_f32 v158, v120, v98
  v_mfma_f32_16x16x32_bf16 v[46:49], a[196:199], v[74:77], v[46:49]
  ds_write_b128 v228, v[26:29] offset:512
  v_fmac_f32 v159, v121, v98
  v_fmac_f32 v160, v118, v34
  v_mfma_f32_16x16x32_bf16 v[46:49], a[200:203], v[70:73], v[46:49]
  v_fmac_f32 v161, v119, v34
  v_fmac_f32 v162, v120, v34
  v_mfma_f32_16x16x32_bf16 v[46:49], a[204:207], v[66:69], v[46:49]
  v_fmac_f32 v163, v121, v34
  v_fmac_f32 v156, v122, v99
  v_mfma_f32_16x16x32_bf16 v[50:53], a[192:195], v[82:85], v[50:53]
  ds_write_b128 v228, v[42:45] offset:1024
  v_fmac_f32 v157, v123, v99
  v_fmac_f32 v158, v124, v99
  v_mfma_f32_16x16x32_bf16 v[50:53], a[196:199], v[78:81], v[50:53]
  v_fmac_f32 v159, v125, v99
  v_fmac_f32 v160, v122, v35
  v_mfma_f32_16x16x32_bf16 v[50:53], a[200:203], v[74:77], v[50:53]
  v_fmac_f32 v161, v123, v35
  v_fmac_f32 v162, v124, v35
  v_mfma_f32_16x16x32_bf16 v[50:53], a[204:207], v[70:73], v[50:53]
  v_fmac_f32 v163, v125, v35
  v_fmac_f32 v156, v126, v100
  v_mfma_f32_16x16x32_bf16 v[50:53], a[208:211], v[66:69], v[50:53]
  ds_write_b128 v228, v[46:49] offset:1536
  v_fmac_f32 v157, v127, v100
  v_fmac_f32 v158, v128, v100
  v_mfma_f32_16x16x32_bf16 v[54:57], a[192:195], v[86:89], v[54:57]
  v_fmac_f32 v159, v129, v100
  v_fmac_f32 v160, v126, v36
  v_mfma_f32_16x16x32_bf16 v[54:57], a[196:199], v[82:85], v[54:57]
  buffer_load_dwordx4 v[164:167], v220, s[44:47], 0 offen sc1
  buffer_load_dwordx4 v[168:171], v220, s[44:47], s67 offen sc1
  s_movk_i32 s65, 8192
  buffer_load_dwordx4 v[172:175], v220, s[44:47], s65 offen sc1
  s_movk_i32 s65, 12288
  buffer_load_dwordx4 v[176:179], v220, s[44:47], s65 offen sc1
  v_fmac_f32 v161, v127, v36
  v_fmac_f32 v162, v128, v36
  v_mfma_f32_16x16x32_bf16 v[54:57], a[200:203], v[78:81], v[54:57]
  v_fmac_f32 v163, v129, v36
  v_fmac_f32 v156, v140, v101
  v_mfma_f32_16x16x32_bf16 v[54:57], a[204:207], v[74:77], v[54:57]
  v_fmac_f32 v157, v141, v101
  v_fmac_f32 v158, v142, v101
  v_mfma_f32_16x16x32_bf16 v[54:57], a[208:211], v[70:73], v[54:57]
  ds_write_b128 v228, v[50:53] offset:2048
  v_fmac_f32 v159, v143, v101
  v_fmac_f32 v160, v140, v37
  v_mfma_f32_16x16x32_bf16 v[54:57], a[212:215], v[66:69], v[54:57]
  v_fmac_f32 v161, v141, v37
  v_fmac_f32 v162, v142, v37
  v_mfma_f32_16x16x32_bf16 v[58:61], a[192:195], v[90:93], v[58:61]
  v_fmac_f32 v163, v143, v37
  v_mfma_f32_16x16x32_bf16 v[58:61], a[196:199], v[86:89], v[58:61]
  s_waitcnt vmcnt(4)
  s_mov_b32 s65, 65536
  buffer_store_dword v253, v219, s[44:47], s65 offen sc1
  v_permlane32_swap_b32 v156, v160
  v_permlane32_swap_b32 v157, v161
  v_mfma_f32_16x16x32_bf16 v[58:61], a[200:203], v[82:85], v[58:61]
  v_permlane32_swap_b32 v158, v162
  v_permlane32_swap_b32 v159, v163
  v_mfma_f32_16x16x32_bf16 v[58:61], a[204:207], v[78:81], v[58:61]
  v_add_f32 v156, v156, v160
  v_add_f32 v157, v157, v161
  v_mfma_f32_16x16x32_bf16 v[58:61], a[208:211], v[74:77], v[58:61]
  ds_write_b128 v228, v[54:57] offset:2560
  v_add_f32 v158, v158, v162
  v_add_f32 v159, v159, v163
  v_mfma_f32_16x16x32_bf16 v[58:61], a[212:215], v[70:73], v[58:61]
  ds_write_b32 v226, v156 offset:10240
  ds_write_b32 v226, v157 offset:10256
  v_mfma_f32_16x16x32_bf16 v[58:61], a[216:219], v[66:69], v[58:61]
  ds_write_b32 v226, v158 offset:10272
  ds_write_b32 v226, v159 offset:10288
  v_mfma_f32_16x16x32_bf16 v[62:65], a[192:195], v[94:97], v[62:65]
  v_mfma_f32_16x16x32_bf16 v[62:65], a[196:199], v[90:93], v[62:65]
  v_perm_b32 v6, v145, v144, s68
  v_perm_b32 v7, v147, v146, s68
  v_mfma_f32_16x16x32_bf16 v[62:65], a[200:203], v[86:89], v[62:65]
  v_perm_b32 v8, v149, v148, s68
  v_perm_b32 v9, v151, v150, s68
  v_mfma_f32_16x16x32_bf16 v[62:65], a[204:207], v[82:85], v[62:65]
  v_perm_b32 v10, v145, v144, s69
  v_perm_b32 v11, v147, v146, s69
  v_mfma_f32_16x16x32_bf16 v[62:65], a[208:211], v[78:81], v[62:65]
  ds_write_b128 v228, v[58:61] offset:3072
  v_perm_b32 v12, v149, v148, s69
  v_perm_b32 v13, v151, v150, s69
  v_mfma_f32_16x16x32_bf16 v[62:65], a[212:215], v[74:77], v[62:65]
  ds_bpermute_b32 v14, v238, v6
  ds_bpermute_b32 v15, v238, v7
  v_mfma_f32_16x16x32_bf16 v[62:65], a[216:219], v[70:73], v[62:65]
  ds_bpermute_b32 v16, v238, v8
  ds_bpermute_b32 v17, v238, v9
  v_mfma_f32_16x16x32_bf16 v[62:65], a[220:223], v[66:69], v[62:65]
  ds_bpermute_b32 v18, v238, v10
  ds_bpermute_b32 v19, v238, v11
  s_nop 5
  ds_write_b128 v228, v[62:65] offset:3584
  ds_bpermute_b32 v20, v238, v12
  ds_bpermute_b32 v21, v238, v13
  s_waitcnt lgkmcnt(0)
  s_barrier
  ds_read_b128 v[2:5], v225 offset:0
  ds_read_b128 v[6:9], v225 offset:4096
  ds_read_b128 v[10:13], v225 offset:20480
  ds_read_b128 v[22:25], v225 offset:24576
  ds_read_b128 v[26:29], v224 offset:0
  ds_read_b128 v[30:33], v224 offset:4096
  ds_read_b128 v[34:37], v224 offset:20480
  ds_read_b128 v[38:41], v224 offset:24576
  v_lshrrev_b32 v249, 3, v255
  v_lshl_add_u32 v249, v249, 3, s89
  ds_read_b64 v[50:51], v249 offset:11264
  ds_read_b64 v[52:53], v249 offset:11328
  ds_read_b64 v[54:55], v249 offset:11392
  s_waitcnt lgkmcnt(7)
  v_pk_add_f32 v[2:3], v[2:3], v[10:11]
  v_pk_add_f32 v[4:5], v[4:5], v[12:13]
  v_pk_add_f32 v[6:7], v[6:7], v[22:23]
  v_pk_add_f32 v[8:9], v[8:9], v[24:25]
  v_cvt_pk_bf16_f32 v42, v2, v3
  v_cvt_pk_bf16_f32 v43, v4, v5
  v_cvt_pk_bf16_f32 v44, v6, v7
  v_cvt_pk_bf16_f32 v45, v8, v9
  buffer_store_dwordx4 v[42:45], v250, s[44:47], s84 offen
  s_waitcnt lgkmcnt(3)
  v_pk_add_f32 v[26:27], v[26:27], v[34:35]
  v_pk_add_f32 v[28:29], v[28:29], v[36:37]
  v_pk_add_f32 v[30:31], v[30:31], v[38:39]
  v_pk_add_f32 v[32:33], v[32:33], v[40:41]
  v_cvt_pk_bf16_f32 v46, v26, v27
  v_cvt_pk_bf16_f32 v47, v28, v29
  v_cvt_pk_bf16_f32 v48, v30, v31
  v_cvt_pk_bf16_f32 v49, v32, v33
  buffer_store_dwordx4 v[46:49], v250, s[44:47], s85 offen
  ds_read_b64_tr_b16 a[32:33], v244 offset:0
  ds_read_b64_tr_b16 a[34:35], v244 offset:1024
  ds_read_b64_tr_b16 a[36:37], v243 offset:0
  ds_read_b64_tr_b16 a[38:39], v243 offset:1024
  ds_read_b64_tr_b16 a[40:41], v244 offset:2048
  ds_read_b64_tr_b16 a[42:43], v244 offset:3072
  ds_read_b64_tr_b16 a[44:45], v243 offset:2048
  ds_read_b64_tr_b16 a[46:47], v243 offset:3072
  s_branch L_pskip0
.p2align 12
L_pstub0:
  s_branch L_pback0
L_pskip0:
  s_add_u32 m0, s89, 4096
  s_add_u32 s83, s88, 229376
  buffer_load_dwordx4 v246, s[28:31], s83 offen lds
  buffer_load_dwordx4 v245, s[28:31], s83 offen offset:1024 lds
  s_add_u32 m0, s89, 6144
  s_add_u32 s83, s88, 245760
  buffer_load_dwordx4 v246, s[28:31], s83 offen lds
  buffer_load_dwordx4 v245, s[28:31], s83 offen offset:1024 lds
  s_waitcnt lgkmcnt(4)
  s_add_u32 m0, s89, 0
  s_add_u32 s83, s88, 262144
  buffer_load_dwordx4 v246, s[28:31], s83 offen lds
  buffer_load_dwordx4 v245, s[28:31], s83 offen offset:1024 lds
  s_waitcnt lgkmcnt(0)
  s_add_u32 m0, s89, 2048
  s_add_u32 s83, s88, 344064
  buffer_load_dwordx4 v246, s[28:31], s83 offen lds
  buffer_load_dwordx4 v245, s[28:31], s83 offen offset:1024 lds
  s_waitcnt vmcnt(11)
chk_9:
  v_min3_u32 v239, v253, v165, v167
  v_max3_u32 v238, v253, v165, v167
  v_min3_u32 v239, v239, v169, v171
  v_max3_u32 v238, v238, v169, v171
  v_min3_u32 v239, v239, v173, v175
  v_max3_u32 v238, v238, v173, v175
  v_min3_u32 v239, v239, v177, v179
  v_max3_u32 v238, v238, v177, v179
  v_cmp_ne_u32 vcc, v239, v238
  s_nop 4
  s_cbranch_vccz ok_11
slow_10:
  s_add_u32 s58, s58, 1
  s_cmp_gt_u32 s58, 200000
  s_cbranch_scc1 ok_11
  buffer_load_dwordx4 v[164:167], v220, s[44:47], 0 offen sc1
  buffer_load_dwordx4 v[168:171], v220, s[44:47], s67 offen sc1
  s_movk_i32 s65, 8192
  buffer_load_dwordx4 v[172:175], v220, s[44:47], s65 offen sc1
  s_movk_i32 s65, 12288
  buffer_load_dwordx4 v[176:179], v220, s[44:47], s65 offen sc1
  s_waitcnt vmcnt(0)
  s_branch chk_9
ok_11:
  v_and_b32 v165, s70, v166
  v_lshlrev_b32 v167, 16, v166
  v_lshlrev_b32 v166, 16, v164
  v_and_b32 v164, s70, v164
  v_and_b32 v169, s70, v170
  v_lshlrev_b32 v171, 16, v170
  v_lshlrev_b32 v170, 16, v168
  v_and_b32 v168, s70, v168
  v_and_b32 v173, s70, v174
  v_lshlrev_b32 v175, 16, v174
  v_lshlrev_b32 v174, 16, v172
  v_and_b32 v172, s70, v172
  v_and_b32 v177, s70, v178
  v_lshlrev_b32 v179, 16, v178
  v_lshlrev_b32 v178, 16, v176
  v_and_b32 v176, s70, v176
  v_pk_mul_f32 v[166:167], v[166:167], v[164:165]
  v_pk_mul_f32 v[170:171], v[170:171], v[168:169]
  v_pk_mul_f32 v[174:175], v[174:175], v[172:173]
  v_pk_mul_f32 v[178:179], v[178:179], v[176:177]
  v_and_b32 v131, s70, v130
  v_lshlrev_b32 v130, 16, v130
  v_pk_mul_f32 v[50:51], v[50:51], v[54:55]
  v_pk_mul_f32 v[52:53], v[52:53], v[54:55]
  s_waitcnt vmcnt(8)
  s_mov_b32 s65, 8519680
  buffer_store_dword v235, v237, s[44:47], s65 offen
  v_lshlrev_b32 v26, 16, v14
  v_and_b32 v27, s70, v14
  v_and_b32 v42, s70, v135
  v_lshlrev_b32 v43, 16, v135
  v_lshlrev_b32 v28, 16, v15
  v_and_b32 v29, s70, v15
  v_and_b32 v44, s70, v134
  v_lshlrev_b32 v45, 16, v134
  v_lshlrev_b32 v30, 16, v16
  v_and_b32 v31, s70, v16
  v_and_b32 v46, s70, v133
  v_lshlrev_b32 v47, 16, v133
  v_lshlrev_b32 v32, 16, v17
  v_and_b32 v33, s70, v17
  v_and_b32 v48, s70, v132
  v_lshlrev_b32 v49, 16, v132
  v_pk_fma_f32 v[2:3], v[26:27], v[164:165], v[166:167]
  v_pk_fma_f32 v[4:5], v[28:29], v[168:169], v[170:171]
  v_pk_fma_f32 v[6:7], v[30:31], v[172:173], v[174:175]
  v_pk_fma_f32 v[8:9], v[32:33], v[176:177], v[178:179]
  v_pk_mul_f32 v[42:43], v[42:43], v[130:131] op_sel:[0,0] op_sel_hi:[1,0]
  v_pk_mul_f32 v[44:45], v[44:45], v[130:131] op_sel:[0,0] op_sel_hi:[1,0]
  v_pk_mul_f32 v[46:47], v[46:47], v[130:131] op_sel:[0,0] op_sel_hi:[1,0]
  v_pk_mul_f32 v[48:49], v[48:49], v[130:131] op_sel:[0,0] op_sel_hi:[1,0]
  v_pk_fma_f32 v[2:3], v[2:3], v[52:53], v[50:51] op_sel:[0,0,0] op_sel_hi:[1,0,0]
  v_pk_fma_f32 v[4:5], v[4:5], v[52:53], v[50:51] op_sel:[0,0,0] op_sel_hi:[1,0,0]
  v_pk_fma_f32 v[6:7], v[6:7], v[52:53], v[50:51] op_sel:[0,0,0] op_sel_hi:[1,0,0]
  v_pk_fma_f32 v[8:9], v[8:9], v[52:53], v[50:51] op_sel:[0,0,0] op_sel_hi:[1,0,0]
  v_pk_fma_f32 v[26:27], v[2:3], v[42:43], v[26:27]
  v_pk_fma_f32 v[28:29], v[4:5], v[44:45], v[28:29]
  v_pk_fma_f32 v[30:31], v[6:7], v[46:47], v[30:31]
  v_pk_fma_f32 v[32:33], v[8:9], v[48:49], v[32:33]
  s_mov_b32 s65, 8519680
  buffer_load_dword v232, v234, s[44:47], s65 offen sc1
  s_mov_b32 s65, 65536
  buffer_load_dword v241, v240, s[44:47], s65 offen sc1
  v_lshlrev_b32 v34, 16, v18
  v_and_b32 v35, s70, v18
  v_and_b32 v42, s70, v139
  v_lshlrev_b32 v43, 16, v139
  v_lshlrev_b32 v36, 16, v19
  v_and_b32 v37, s70, v19
  v_and_b32 v44, s70, v138
  v_lshlrev_b32 v45, 16, v138
  v_lshlrev_b32 v38, 16, v20
  v_and_b32 v39, s70, v20
  v_and_b32 v46, s70, v137
  v_lshlrev_b32 v47, 16, v137
  v_lshlrev_b32 v40, 16, v21
  v_and_b32 v41, s70, v21
  v_and_b32 v48, s70, v136
  v_lshlrev_b32 v49, 16, v136
  v_pk_fma_f32 v[10:11], v[34:35], v[164:165], v[166:167]
  v_pk_fma_f32 v[12:13], v[36:37], v[168:169], v[170:171]
  v_pk_fma_f32 v[22:23], v[38:39], v[172:173], v[174:175]
  v_pk_fma_f32 v[24:25], v[40:41], v[176:177], v[178:179]
  v_pk_mul_f32 v[42:43], v[42:43], v[130:131] op_sel:[0,1] op_sel_hi:[1,1]
  v_pk_mul_f32 v[44:45], v[44:45], v[130:131] op_sel:[0,1] op_sel_hi:[1,1]
  v_pk_mul_f32 v[46:47], v[46:47], v[130:131] op_sel:[0,1] op_sel_hi:[1,1]
  v_pk_mul_f32 v[48:49], v[48:49], v[130:131] op_sel:[0,1] op_sel_hi:[1,1]
  v_pk_fma_f32 v[10:11], v[10:11], v[52:53], v[50:51] op_sel:[0,1,1] op_sel_hi:[1,1,1]
  v_pk_fma_f32 v[12:13], v[12:13], v[52:53], v[50:51] op_sel:[0,1,1] op_sel_hi:[1,1,1]
  v_pk_fma_f32 v[22:23], v[22:23], v[52:53], v[50:51] op_sel:[0,1,1] op_sel_hi:[1,1,1]
  v_pk_fma_f32 v[24:25], v[24:25], v[52:53], v[50:51] op_sel:[0,1,1] op_sel_hi:[1,1,1]
  v_pk_fma_f32 v[34:35], v[10:11], v[42:43], v[34:35]
  v_pk_fma_f32 v[36:37], v[12:13], v[44:45], v[36:37]
  v_pk_fma_f32 v[38:39], v[22:23], v[46:47], v[38:39]
  v_pk_fma_f32 v[40:41], v[24:25], v[48:49], v[40:41]
  s_waitcnt vmcnt(1)
  v_cmp_ne_u32 vcc, v232, v235
  s_nop 4
  s_cbranch_vccz lok_13
lslow_12:
  s_mov_b32 s73, 0
lagain_15:
  s_add_u32 s58, s58, 1
  s_cmp_gt_u32 s58, 200000
  s_cbranch_scc1 lok_13
  s_mov_b32 s65, 8519680
  buffer_load_dword v232, v234, s[44:47], s65 offen sc1
  s_waitcnt vmcnt(0)
  v_cmp_ne_u32 vcc, v232, v235
  s_nop 4
  s_cbranch_vccz lok_13
  s_cmp_ge_u32 s73, 0x10000
  s_cbranch_scc1 lnorel_16
  s_add_u32 s73, s73, 1
  s_cmp_ge_u32 s73, 40
  s_cbranch_scc1 lrel_14
  v_cmp_eq_u32 vcc, v232, v253
  s_nop 4
  s_cbranch_vccz lagain_15
lrel_14:
  buffer_wbl2 sc1
  s_waitcnt vmcnt(0)
  s_mov_b32 s65, 8519680
  buffer_store_dword v253, v237, s[44:47], s65 offen sc1
  s_mov_b32 s73, 0x10000
lnorel_16:
  v_cmp_ne_u32 vcc, v232, v235
  v_cmp_ne_u32 s[54:55], v232, v253
  s_nop 3
  s_and_b64 s[54:55], vcc, s[54:55]
  s_cbranch_scc1 lagain_15
  s_waitcnt vmcnt(0)
  s_branch lok_13
lok_13:
  buffer_load_dwordx4 v[14:17], v236, s[44:47], 0 offen sc1
  buffer_load_dwordx4 v[18:21], v236, s[44:47], s67 offen sc1
  s_waitcnt vmcnt(2)
chk_17:
  v_cmp_ne_u32 vcc, v241, v253
  s_nop 4
  s_cbranch_vccz ok_19
slow_18:
  s_add_u32 s58, s58, 1
  s_cmp_gt_u32 s58, 200000
  s_cbranch_scc1 ok_19
  s_mov_b32 s65, 65536
  buffer_load_dword v241, v240, s[44:47], s65 offen sc1
  s_waitcnt vmcnt(0)
  s_branch chk_17
ok_19:
  s_add_u32 m0, s95, 0
  s_add_u32 s59, s94, 0
  buffer_load_dwordx4 v254, s[44:47], s59 offen offset:0 sc1 lds
  buffer_load_dwordx4 v254, s[44:47], s59 offen offset:1024 sc1 lds
  buffer_load_dwordx4 v254, s[44:47], s59 offen offset:2048 sc1 lds
  buffer_load_dwordx4 v254, s[44:47], s59 offen offset:3072 sc1 lds
  s_add_u32 m0, s95, 16384
  s_add_u32 s59, s94, 16384
  buffer_load_dwordx4 v254, s[44:47], s59 offen offset:0 sc1 lds
  buffer_load_dwordx4 v254, s[44:47], s59 offen offset:1024 sc1 lds
  buffer_load_dwordx4 v254, s[44:47], s59 offen offset:2048 sc1 lds
  buffer_load_dwordx4 v254, s[44:47], s59 offen offset:3072 sc1 lds
  v_and_b32 v249, 127, v0
  v_lshlrev_b32 v249, 2, v249
  v_add_u32 v249, 92160, v249
  v_add_u32 v248, 40960, v249
  ds_read_b32 v42, v249 offset:0
  ds_read_b32 v43, v249 offset:512
  ds_read_b32 v44, v249 offset:20480
  ds_read_b32 v45, v249 offset:20992
  ds_read_b32 v46, v248 offset:0
  ds_read_b32 v47, v248 offset:512
  ds_read_b32 v48, v248 offset:20480
  ds_read_b32 v49, v248 offset:20992
  s_lshl_b32 s59, s82, 3
  s_add_u32 s59, s59, s3
  s_lshl_b32 s59, s59, 1
  s_add_u32 s59, s59, s80
  s_mul_i32 s59, s59, 896
  s_add_u32 s59, s59, 720896
  v_lshlrev_b32 v249, 3, v0
  v_mov_b32 v247, 2147483648
  v_cmp_gt_u32 vcc, 112, v0
  s_nop 1
  v_cndmask_b32 v249, v247, v249, vcc
  s_waitcnt lgkmcnt(0)
  v_pk_add_f32 v[42:43], v[42:43], v[44:45]
  v_pk_add_f32 v[46:47], v[46:47], v[48:49]
  v_pk_add_f32 v[42:43], v[42:43], v[46:47]
  buffer_store_dwordx2 v[42:43], v249, s[44:47], s59 offen sc1
  s_waitcnt vmcnt(10)
  v_lshlrev_b32 v42, 16, v14
  v_and_b32 v43, s70, v14
  v_lshlrev_b32 v44, 16, v15
  v_and_b32 v45, s70, v15
  v_lshlrev_b32 v46, 16, v16
  v_and_b32 v47, s70, v16
  v_lshlrev_b32 v48, 16, v17
  v_and_b32 v49, s70, v17
  v_pk_fma_f32 v[26:27], v[2:3], v[42:43], v[26:27]
  v_pk_fma_f32 v[28:29], v[4:5], v[44:45], v[28:29]
  v_pk_fma_f32 v[30:31], v[6:7], v[46:47], v[30:31]
  v_pk_fma_f32 v[32:33], v[8:9], v[48:49], v[32:33]
  v_cvt_pk_bf16_f32 v14, v26, v27
  v_cvt_pk_bf16_f32 v15, v28, v29
  v_cvt_pk_bf16_f32 v16, v30, v31
  v_cvt_pk_bf16_f32 v17, v32, v33
  ds_write_b128 v223, v[14:17] offset:8192
  s_waitcnt vmcnt(9)
  v_lshlrev_b32 v42, 16, v18
  v_and_b32 v43, s70, v18
  v_lshlrev_b32 v44, 16, v19
  v_and_b32 v45, s70, v19
  v_lshlrev_b32 v46, 16, v20
  v_and_b32 v47, s70, v20
  v_lshlrev_b32 v48, 16, v21
  v_and_b32 v49, s70, v21
  v_pk_fma_f32 v[34:35], v[10:11], v[42:43], v[34:35]
  v_pk_fma_f32 v[36:37], v[12:13], v[44:45], v[36:37]
  v_pk_fma_f32 v[38:39], v[22:23], v[46:47], v[38:39]
  v_pk_fma_f32 v[40:41], v[24:25], v[48:49], v[40:41]
  v_cvt_pk_bf16_f32 v18, v34, v35
  v_cvt_pk_bf16_f32 v19, v36, v37
  v_cvt_pk_bf16_f32 v20, v38, v39
  v_cvt_pk_bf16_f32 v21, v40, v41
  ds_write_b128 v223, v[18:21] offset:8256
  ds_read_b64_tr_b16 v[50:51], v222 offset:8192
  ds_read_b64_tr_b16 v[52:53], v222 offset:8448
  ds_read_b64_tr_b16 v[54:55], v222 offset:9216
  ds_read_b64_tr_b16 v[56:57], v222 offset:9472
  v_lshl_add_u32 v249, v255, 3, s89
  s_waitcnt lgkmcnt(2)
  buffer_store_dwordx4 v[50:53], v254, s[44:47], s90 offen sc1
  s_waitcnt lgkmcnt(0)
  buffer_store_dwordx4 v[54:57], v254, s[44:47], s91 offen sc1
  v_dot2_f32_bf16 v58, v50, s71, 0
  v_dot2_f32_bf16 v59, v50, v50, 0
  v_dot2_f32_bf16 v60, v54, s71, 0
  v_dot2_f32_bf16 v61, v54, v54, 0
  v_dot2_f32_bf16 v58, v51, s71, v58
  v_dot2_f32_bf16 v59, v51, v51, v59
  v_dot2_f32_bf16 v60, v55, s71, v60
  v_dot2_f32_bf16 v61, v55, v55, v61
  v_dot2_f32_bf16 v58, v52, s71, v58
  v_dot2_f32_bf16 v59, v52, v52, v59
  v_dot2_f32_bf16 v60, v56, s71, v60
  v_dot2_f32_bf16 v61, v56, v56, v61
  v_dot2_f32_bf16 v58, v53, s71, v58
  v_dot2_f32_bf16 v59, v53, v53, v59
  v_dot2_f32_bf16 v60, v57, s71, v60
  v_dot2_f32_bf16 v61, v57, v57, v61
  s_nop 1
  v_permlane32_swap_b32 v58, v60
  v_permlane32_swap_b32 v59, v61
  v_pk_add_f32 v[58:59], v[58:59], v[60:61]
  ds_write_b64 v249, v[58:59] offset:11776
  s_add_u32 m0, s95, 32768
  s_add_u32 s59, s94, 32768
  buffer_load_dwordx4 v254, s[44:47], s59 offen offset:0 sc1 lds
  buffer_load_dwordx4 v254, s[44:47], s59 offen offset:1024 sc1 lds
  buffer_load_dwordx4 v254, s[44:47], s59 offen offset:2048 sc1 lds
  buffer_load_dwordx4 v254, s[44:47], s59 offen offset:3072 sc1 lds
  s_add_u32 m0, s95, 49152
  s_add_u32 s59, s94, 49152
  buffer_load_dwordx4 v254, s[44:47], s59 offen offset:0 sc1 lds
  buffer_load_dwordx4 v254, s[44:47], s59 offen offset:1024 sc1 lds
  buffer_load_dwordx4 v254, s[44:47], s59 offen offset:2048 sc1 lds
  buffer_load_dwordx4 v254, s[44:47], s59 offen offset:3072 sc1 lds
  ds_read_b64_tr_b16 a[48:49], v244 offset:4096
  ds_read_b64_tr_b16 a[50:51], v244 offset:5120
  ds_read_b64_tr_b16 a[52:53], v243 offset:4096
  ds_read_b64_tr_b16 a[54:55], v243 offset:5120
  ds_read_b64_tr_b16 a[56:57], v244 offset:6144
  ds_read_b64_tr_b16 a[58:59], v244 offset:7168
  ds_read_b64_tr_b16 a[60:61], v243 offset:6144
  ds_read_b64_tr_b16 a[62:63], v243 offset:7168
  ds_read_b64_tr_b16 a[64:65], v244 offset:0
  ds_read_b64_tr_b16 a[66:67], v244 offset:1024
  ds_read_b64_tr_b16 a[68:69], v243 offset:0
  ds_read_b64_tr_b16 a[70:71], v243 offset:1024
  ds_read_b64_tr_b16 a[72:73], v244 offset:2048
  ds_read_b64_tr_b16 a[74:75], v244 offset:3072
  ds_read_b64_tr_b16 a[76:77], v243 offset:2048
  ds_read_b64_tr_b16 a[78:79], v243 offset:3072
  s_waitcnt vmcnt(8)
  s_mov_b32 s65, 262144
  buffer_store_dword v253, v218, s[44:47], s65 offen sc1
  s_and_b32 s62, s57, 1
  s_lshl_b32 s62, s62, 5
  s_lshl_b32 s96, s87, 6
  s_add_u32 s96, s96, s62
  s_lshl_b32 s59, s96, 3
  s_add_u32 s59, s59, 671744
  v_lshl_add_u32 v239, v251, 3, s59
  v_lshl_add_u32 v239, v252, 13, v239
  buffer_load_dwordx2 v[2:3], v239, s[44:47], 0 offen sc1
  buffer_load_dwordx2 v[4:5], v239, s[44:47], s67 offen sc1
  s_waitcnt lgkmcnt(0)
  s_barrier
  v_lshlrev_b32 v249, 3, v255
  v_add_u32 v249, 93696, v249
  ds_read_b64 v[6:7], v249 offset:0
  ds_read_b64 v[8:9], v249 offset:20480
  ds_read_b64 v[10:11], v249 offset:40960
  ds_read_b64 v[12:13], v249 offset:61440
  s_waitcnt lgkmcnt(0)
  v_pk_add_f32 v[6:7], v[6:7], v[8:9]
  v_pk_add_f32 v[10:11], v[10:11], v[12:13]
  v_add_f32 v8, v7, v11
  v_add_f32 v6, v6, v10
  v_mov_b32 v7, v253
  v_mov_b32 v9, v253
  buffer_store_dwordx4 v[6:9], v221, s[44:47], 0 offen sc1
  s_add_u32 m0, s95, 65536
  s_add_u32 s59, s94, 65536
  buffer_load_dwordx4 v254, s[44:47], s59 offen offset:0 sc1 lds
  buffer_load_dwordx4 v254, s[44:47], s59 offen offset:1024 sc1 lds
  buffer_load_dwordx4 v254, s[44:47], s59 offen offset:2048 sc1 lds
  buffer_load_dwordx4 v254, s[44:47], s59 offen offset:3072 sc1 lds
  s_barrier
  s_add_u32 m0, s95, 81920
  s_add_u32 s59, s94, 81920
  buffer_load_dwordx4 v254, s[44:47], s59 offen offset:0 sc1 lds
  buffer_load_dwordx4 v254, s[44:47], s59 offen offset:1024 sc1 lds
  buffer_load_dwordx4 v254, s[44:47], s59 offen offset:2048 sc1 lds
  buffer_load_dwordx4 v254, s[44:47], s59 offen offset:3072 sc1 lds
  s_add_u32 m0, s95, 98304
  s_add_u32 s59, s94, 98304
  buffer_load_dwordx4 v254, s[44:47], s59 offen offset:0 sc1 lds
  buffer_load_dwordx4 v254, s[44:47], s59 offen offset:1024 sc1 lds
  buffer_load_dwordx4 v254, s[44:47], s59 offen offset:2048 sc1 lds
  buffer_load_dwordx4 v254, s[44:47], s59 offen offset:3072 sc1 lds
  s_mov_b32 s65, 262144
  buffer_load_dword v238, v217, s[44:47], s65 offen sc1
  s_add_u32 m0, s95, 114688
  s_add_u32 s59, s94, 114688
  buffer_load_dwordx4 v254, s[44:47], s59 offen offset:0 sc1 lds
  buffer_load_dwordx4 v254, s[44:47], s59 offen offset:1024 sc1 lds
  buffer_load_dwordx4 v254, s[44:47], s59 offen offset:2048 sc1 lds
  buffer_load_dwordx4 v254, s[44:47], s59 offen offset:3072 sc1 lds
  s_lshl_b32 s10, s92, 2
  s_add_u32 s10, s10, s57
  s_lshl_b32 s8, s10, 15
  s_add_u32 s8, s8, 9437184
  s_mul_i32 s9, s57, 7168
  s_add_u32 s9, s9, 131072
  s_mul_i32 s11, s10, 112
  s_mul_i32 s59, s93, 7
  s_add_u32 s11, s11, s59
  s_lshl_b32 s11, s11, 10
  s_add_u32 s11, s11, 17825792
  s_lshl_b32 s12, s10, 12
  s_add_u32 s12, s12, 8650752
  v_bfe_u32 v249, v255, 2, 3
  v_lshlrev_b32 v237, 7, v249
  v_bfe_u32 v249, v255, 4, 1
  v_xor_b32 v249, v249, v252
  v_lshl_add_u32 v237, v249, 6, v237
  v_and_b32 v249, 3, v255
  v_lshl_add_u32 v237, v249, 4, v237
  v_add_u32 v236, 65536, v237
  v_lshlrev_b32 v235, 4, v251
  v_add_u32 v235, 159744, v235
  v_add_u32 v234, 4096, v254
  s_mul_i32 s13, s93, 14336
  s_mul_i32 s59, s57, 448
  s_add_u32 s13, s13, s59
  s_add_u32 s13, s13, 720896
  v_min_u32 v249, 27, v251
  v_mul_u32_u24 v232, 7168, v252
  v_lshl_add_u32 v232, v249, 4, v232
  s_and_b32 s59, s57, 1
  s_mul_i32 s59, s59, 56
  v_lshl_add_u32 v249, v249, 1, v252
  v_add_u32 v249, s59, v249
  s_lshr_b32 s59, s57, 1
  s_lshl_b32 s59, s59, 8
  s_add_u32 s59, s59, 159744
  v_and_b32 v248, 15, v249
  v_lshl_add_u32 v231, v248, 4, s59
  v_lshrrev_b32 v249, 4, v249
  v_lshl_add_u32 v231, v249, 9, v231
  s_lshl_b32 s59, s10, 4
  s_add_u32 s59, s59, s93
  s_lshl_b32 s59, s59, 5
  v_mov_b32 v233, 2147483648
  v_writelane_b32 v233, s59, 0
  s_sub_u32 s59, s9, s89
  s_mov_b32 s89, s9
  v_add_u32 v244, s59, v244
  v_add_u32 v243, s59, v243
  s_waitcnt vmcnt(18)
chk_20:
  v_min3_u32 v230, v253, v3, v5
  v_max3_u32 v229, v253, v3, v5
  v_cmp_ne_u32 vcc, v230, v229
  s_nop 4
  s_cbranch_vccz ok_22
slow_21:
  s_add_u32 s58, s58, 1
  s_cmp_gt_u32 s58, 200000
  s_cbranch_scc1 ok_22
  buffer_load_dwordx2 v[2:3], v239, s[44:47], 0 offen sc1
  buffer_load_dwordx2 v[4:5], v239, s[44:47], s67 offen sc1
  s_waitcnt vmcnt(0)
  s_branch chk_20
ok_22:
  v_add_f32 v2, v2, v4
  v_mov_b32 v3, v2
  s_nop 1
  v_permlane32_swap_b32 v2, v3
  v_add_f32 v2, v2, v3
  v_cvt_pk_bf16_f32 v242, v2, v2
  v_and_b32 v242, s70, v242
  s_waitcnt vmcnt(4)
chk_23:
  v_cmp_ne_u32 vcc, v238, v253
  s_nop 4
  s_cbranch_vccz ok_25
slow_24:
  s_add_u32 s58, s58, 1
  s_cmp_gt_u32 s58, 200000
  s_cbranch_scc1 ok_25
  s_mov_b32 s65, 262144
  buffer_load_dword v238, v217, s[44:47], s65 offen sc1
  s_waitcnt vmcnt(0)
  s_branch chk_23
ok_25:
  buffer_load_dwordx4 v[2:5], v254, s[44:47], s8 offen offset:0 sc1
  buffer_load_dwordx4 v[86:89], v254, s[44:47], s8 offen offset:1024 sc1
  buffer_load_dwordx4 v[90:93], v254, s[44:47], s8 offen offset:2048 sc1
  buffer_load_dwordx4 v[94:97], v254, s[44:47], s8 offen offset:3072 sc1
  s_add_u32 s8, s8, 4096
  buffer_load_dwordx4 v[98:101], v254, s[44:47], s8 offen offset:0 sc1
  buffer_load_dwordx4 v[102:105], v254, s[44:47], s8 offen offset:1024 sc1
  buffer_load_dwordx4 v[106:109], v254, s[44:47], s8 offen offset:2048 sc1
  buffer_load_dwordx4 v[110:113], v254, s[44:47], s8 offen offset:3072 sc1
  s_barrier
  ds_read_b128 a[224:227], v237 offset:0
  ds_read_b128 a[228:231], v237 offset:1024
  ds_read_b128 a[232:235], v237 offset:2048
  ds_read_b128 a[236:239], v237 offset:3072
  ds_read_b128 a[240:243], v237 offset:4096
  ds_read_b128 a[244:247], v237 offset:5120
  s_waitcnt vmcnt(7) lgkmcnt(4)
  v_mfma_f32_32x32x16_bf16 v[6:21], a[224:227], v[2:5], 0
  ds_read_b128 a[248:251], v237 offset:6144
  s_add_u32 s8, s8, 4096
  buffer_load_dwordx4 v[114:117], v254, s[44:47], s8 offen offset:0 sc1
  v_mfma_f32_32x32x16_bf16 v[22:37], a[228:231], v[2:5], 0
  ds_read_b128 a[252:255], v237 offset:7168
  s_waitcnt lgkmcnt(4)
  v_mfma_f32_32x32x16_bf16 v[38:53], a[232:235], v[2:5], 0
  ds_read_b128 a[224:227], v237 offset:8192
  buffer_load_dwordx4 v[118:121], v254, s[44:47], s8 offen offset:1024 sc1
  s_waitcnt vmcnt(8)
  v_mfma_f32_32x32x16_bf16 v[6:21], a[236:239], v[86:89], v[6:21]
  ds_read_b128 a[228:231], v237 offset:9216
  s_waitcnt lgkmcnt(4)
  v_mfma_f32_32x32x16_bf16 v[22:37], a[240:243], v[86:89], v[22:37]
  ds_read_b128 a[232:235], v237 offset:10240
  buffer_load_dwordx4 v[122:125], v254, s[44:47], s8 offen offset:2048 sc1
  v_mfma_f32_32x32x16_bf16 v[38:53], a[244:247], v[86:89], v[38:53]
  ds_read_b128 a[236:239], v237 offset:11264
  s_waitcnt vmcnt(8) lgkmcnt(4)
  v_mfma_f32_32x32x16_bf16 v[6:21], a[248:251], v[90:93], v[6:21]
  ds_read_b128 a[240:243], v237 offset:12288
  buffer_load_dwordx4 v[126:129], v254, s[44:47], s8 offen offset:3072 sc1
  v_mfma_f32_32x32x16_bf16 v[22:37], a[252:255], v[90:93], v[22:37]
  ds_read_b128 a[244:247], v237 offset:13312
  s_waitcnt lgkmcnt(4)
  v_mfma_f32_32x32x16_bf16 v[38:53], a[224:227], v[90:93], v[38:53]
  ds_read_b128 a[248:251], v237 offset:14336
  s_or_b32 s59, s2, s57
  s_cselect_b32 s59, 2147483648, 0
  v_mov_b32 v249, 2147483648
  v_writelane_b32 v249, s59, 0
  buffer_store_dword v253, v249, s[44:47], 0 offen sc1
  s_waitcnt vmcnt(9)
  v_mfma_f32_32x32x16_bf16 v[6:21], a[228:231], v[94:97], v[6:21]
  ds_read_b128 a[252:255], v237 offset:15360
  s_waitcnt lgkmcnt(4)
  v_mfma_f32_32x32x16_bf16 v[22:37], a[232:235], v[94:97], v[22:37]
  ds_read_b128 a[224:227], v237 offset:16384
  s_add_u32 s8, s8, 4096
  buffer_load_dwordx4 v[130:133], v254, s[44:47], s8 offen offset:0 sc1
  v_mfma_f32_32x32x16_bf16 v[38:53], a[236:239], v[94:97], v[38:53]
  ds_read_b128 a[228:231], v237 offset:17408
  s_waitcnt vmcnt(9) lgkmcnt(4)
  v_mfma_f32_32x32x16_bf16 v[6:21], a[240:243], v[98:101], v[6:21]
  ds_read_b128 a[232:235], v237 offset:18432
  buffer_load_dwordx4 v[134:137], v254, s[44:47], s8 offen offset:1024 sc1
  v_mfma_f32_32x32x16_bf16 v[22:37], a[244:247], v[98:101], v[22:37]
  ds_read_b128 a[236:239], v237 offset:19456
  s_waitcnt lgkmcnt(4)
  v_mfma_f32_32x32x16_bf16 v[38:53], a[248:251], v[98:101], v[38:53]
  ds_read_b128 a[240:243], v237 offset:20480
  buffer_load_dwordx4 v[138:141], v254, s[44:47], s8 offen offset:2048 sc1
  s_waitcnt vmcnt(10)
  v_mfma_f32_32x32x16_bf16 v[6:21], a[252:255], v[102:105], v[6:21]
  ds_read_b128 a[244:247], v237 offset:21504
  s_waitcnt lgkmcnt(4)
  v_mfma_f32_32x32x16_bf16 v[22:37], a[224:227], v[102:105], v[22:37]
  ds_read_b128 a[248:251], v237 offset:22528
  buffer_load_dwordx4 v[142:145], v254, s[44:47], s8 offen offset:3072 sc1
  v_mfma_f32_32x32x16_bf16 v[38:53], a[228:231], v[102:105], v[38:53]
  ds_read_b128 a[252:255], v237 offset:23552
  s_waitcnt vmcnt(10) lgkmcnt(4)
  v_mfma_f32_32x32x16_bf16 v[6:21], a[232:235], v[106:109], v[6:21]
  ds_read_b128 a[224:227], v237 offset:24576
  s_mov_b32 s65, 262144
  buffer_load_dword v241, v240, s[44:47], s65 offen sc1
  v_mfma_f32_32x32x16_bf16 v[22:37], a[236:239], v[106:109], v[22:37]
  ds_read_b128 a[228:231], v237 offset:25600
  s_waitcnt lgkmcnt(4)
  v_mfma_f32_32x32x16_bf16 v[38:53], a[240:243], v[106:109], v[38:53]
  ds_read_b128 a[232:235], v237 offset:26624
  s_add_u32 s8, s8, 4096
  buffer_load_dwordx4 v[146:149], v254, s[44:47], s8 offen offset:0 sc1
  s_waitcnt vmcnt(11)
  v_mfma_f32_32x32x16_bf16 v[6:21], a[244:247], v[110:113], v[6:21]
  ds_read_b128 a[236:239], v237 offset:27648
  s_waitcnt lgkmcnt(4)
  v_mfma_f32_32x32x16_bf16 v[22:37], a[248:251], v[110:113], v[22:37]
  ds_read_b128 a[240:243], v237 offset:28672
  buffer_load_dwordx4 v[150:153], v254, s[44:47], s8 offen offset:1024 sc1
  v_mfma_f32_32x32x16_bf16 v[38:53], a[252:255], v[110:113], v[38:53]
  ds_read_b128 a[244:247], v237 offset:29696
  s_waitcnt vmcnt(11) lgkmcnt(4)
  v_mfma_f32_32x32x16_bf16 v[6:21], a[224:227], v[114:117], v[6:21]
  ds_read_b128 a[248:251], v237 offset:30720
  buffer_load_dwordx4 v[154:157], v254, s[44:47], s8 offen offset:2048 sc1
  v_mfma_f32_32x32x16_bf16 v[22:37], a[228:231], v[114:117], v[22:37]
  ds_read_b128 a[252:255], v237 offset:31744
  s_waitcnt lgkmcnt(4)
  v_mfma_f32_32x32x16_bf16 v[38:53], a[232:235], v[114:117], v[38:53]
  ds_read_b128 a[224:227], v237 offset:32768
  buffer_load_dwordx4 v[158:161], v254, s[44:47], s8 offen offset:3072 sc1
  s_waitcnt vmcnt(12)
  v_mfma_f32_32x32x16_bf16 v[6:21], a[236:239], v[118:121], v[6:21]
  ds_read_b128 a[228:231], v237 offset:33792
  s_waitcnt lgkmcnt(4)
  v_mfma_f32_32x32x16_bf16 v[22:37], a[240:243], v[118:121], v[22:37]
  ds_read_b128 a[232:235], v237 offset:34816
  s_add_u32 m0, s89, 0
  s_add_u32 s83, s88, 360448
  buffer_load_dwordx4 v246, s[28:31], s83 offen lds
  v_mfma_f32_32x32x16_bf16 v[38:53], a[244:247], v[118:121], v[38:53]
  ds_read_b128 a[236:239], v237 offset:35840
  s_waitcnt vmcnt(12) lgkmcnt(4)
  v_mfma_f32_32x32x16_bf16 v[6:21], a[248:251], v[122:125], v[6:21]
  ds_read_b128 a[240:243], v237 offset:36864
  s_add_u32 s8, s8, 4096
  buffer_load_dwordx4 v[162:165], v254, s[44:47], s8 offen offset:0 sc1
  v_mfma_f32_32x32x16_bf16 v[22:37], a[252:255], v[122:125], v[22:37]
  ds_read_b128 a[244:247], v237 offset:37888
  s_waitcnt lgkmcnt(4)
  v_mfma_f32_32x32x16_bf16 v[38:53], a[224:227], v[122:125], v[38:53]
  ds_read_b128 a[248:251], v237 offset:38912
  buffer_load_dwordx4 v[166:169], v254, s[44:47], s8 offen offset:1024 sc1
  s_waitcnt vmcnt(13)
  v_mfma_f32_32x32x16_bf16 v[6:21], a[228:231], v[126:129], v[6:21]
  ds_read_b128 a[252:255], v237 offset:39936
  s_waitcnt lgkmcnt(4)
  v_mfma_f32_32x32x16_bf16 v[22:37], a[232:235], v[126:129], v[22:37]
  ds_read_b128 a[224:227], v237 offset:40960
  s_add_u32 m0, s89, 0
  s_nop 0
  buffer_load_dwordx4 v245, s[28:31], s83 offen offset:1024 lds
  v_mfma_f32_32x32x16_bf16 v[38:53], a[236:239], v[126:129], v[38:53]
  ds_read_b128 a[228:231], v237 offset:41984
  s_waitcnt vmcnt(12) lgkmcnt(4)
  v_mfma_f32_32x32x16_bf16 v[6:21], a[240:243], v[130:133], v[6:21]
  ds_read_b128 a[232:235], v237 offset:43008
  buffer_load_dwordx4 v[170:173], v254, s[44:47], s8 offen offset:2048 sc1
  v_mfma_f32_32x32x16_bf16 v[22:37], a[244:247], v[130:133], v[22:37]
  ds_read_b128 a[236:239], v237 offset:44032
  s_waitcnt lgkmcnt(4)
  v_mfma_f32_32x32x16_bf16 v[38:53], a[248:251], v[130:133], v[38:53]
  ds_read_b128 a[240:243], v237 offset:45056
  buffer_load_dwordx4 v[174:177], v254, s[44:47], s8 offen offset:3072 sc1
  s_waitcnt vmcnt(13)
  v_mfma_f32_32x32x16_bf16 v[6:21], a[252:255], v[134:137], v[6:21]
  ds_read_b128 a[244:247], v237 offset:46080
  s_waitcnt lgkmcnt(4)
  v_mfma_f32_32x32x16_bf16 v[22:37], a[224:227], v[134:137], v[22:37]
  ds_read_b128 a[248:251], v237 offset:47104
  s_add_u32 m0, s89, 2048
  s_add_u32 s83, s88, 376832
  buffer_load_dwordx4 v246, s[28:31], s83 offen lds
  v_mfma_f32_32x32x16_bf16 v[38:53], a[228:231], v[134:137], v[38:53]
  s_branch L_pskip1
.p2align 12
L_pstub1:
  s_branch L_pback1
L_pskip1:
  ds_read_b128 a[252:255], v237 offset:48128
  s_waitcnt vmcnt(11)
chk_26:
  v_cmp_ne_u32 vcc, v241, v253
  s_nop 4
  s_cbranch_vccz ok_28
slow_27:
  s_add_u32 s58, s58, 1
  s_cmp_gt_u32 s58, 200000
  s_cbranch_scc1 ok_28
  s_mov_b32 s65, 262144
  buffer_load_dword v241, v240, s[44:47], s65 offen sc1
  s_waitcnt vmcnt(0)
  s_branch chk_26
ok_28:
  s_waitcnt lgkmcnt(4)
  v_mfma_f32_32x32x16_bf16 v[6:21], a[232:235], v[138:141], v[6:21]
  ds_read_b128 a[224:227], v237 offset:49152
  buffer_load_dwordx4 v[70:73], v232, s[44:47], s13 offen offset:0 sc1
  v_mfma_f32_32x32x16_bf16 v[22:37], a[236:239], v[138:141], v[22:37]
  ds_read_b128 a[228:231], v237 offset:50176
  s_waitcnt lgkmcnt(4)
  v_mfma_f32_32x32x16_bf16 v[38:53], a[240:243], v[138:141], v[38:53]
  ds_read_b128 a[232:235], v237 offset:51200
  buffer_load_dwordx4 v[74:77], v232, s[44:47], s13 offen offset:1792 sc1
  v_mfma_f32_32x32x16_bf16 v[6:21], a[244:247], v[142:145], v[6:21]
  ds_read_b128 a[236:239], v237 offset:52224
  s_waitcnt lgkmcnt(4)
  v_mfma_f32_32x32x16_bf16 v[22:37], a[248:251], v[142:145], v[22:37]
  ds_read_b128 a[240:243], v237 offset:53248
  s_add_u32 s13, s13, 3584
  buffer_load_dwordx4 v[78:81], v232, s[44:47], s13 offen offset:0 sc1
  v_mfma_f32_32x32x16_bf16 v[38:53], a[252:255], v[142:145], v[38:53]
  ds_read_b128 a[244:247], v237 offset:54272
  s_waitcnt vmcnt(13) lgkmcnt(4)
  v_mfma_f32_32x32x16_bf16 v[6:21], a[224:227], v[146:149], v[6:21]
  ds_read_b128 a[248:251], v237 offset:55296
  buffer_load_dwordx4 v[82:85], v232, s[44:47], s13 offen offset:1792 sc1
  v_mfma_f32_32x32x16_bf16 v[22:37], a[228:231], v[146:149], v[22:37]
  ds_read_b128 a[252:255], v237 offset:56320
  s_waitcnt lgkmcnt(4)
  v_mfma_f32_32x32x16_bf16 v[38:53], a[232:235], v[146:149], v[38:53]
  ds_read_b128 a[224:227], v237 offset:57344
  s_add_u32 s8, s8, 4096
  buffer_load_dwordx4 v[178:181], v254, s[44:47], s8 offen offset:0 sc1
  s_waitcnt vmcnt(14)
  v_mfma_f32_32x32x16_bf16 v[6:21], a[236:239], v[150:153], v[6:21]
  ds_read_b128 a[228:231], v237 offset:58368
  s_waitcnt lgkmcnt(4)
  v_mfma_f32_32x32x16_bf16 v[22:37], a[240:243], v[150:153], v[22:37]
  ds_read_b128 a[232:235], v237 offset:59392
  buffer_load_dwordx4 v[182:185], v254, s[44:47], s8 offen offset:1024 sc1
  v_mfma_f32_32x32x16_bf16 v[38:53], a[244:247], v[150:153], v[38:53]
  ds_read_b128 a[236:239], v237 offset:60416
  s_waitcnt vmcnt(14) lgkmcnt(4)
  v_mfma_f32_32x32x16_bf16 v[6:21], a[248:251], v[154:157], v[6:21]
  ds_read_b128 a[240:243], v237 offset:61440
  buffer_load_dwordx4 v[210:213], v254, s[44:47], s12 offen offset:0 sc1
  v_mfma_f32_32x32x16_bf16 v[22:37], a[252:255], v[154:157], v[22:37]
  ds_read_b128 a[244:247], v237 offset:62464
  s_waitcnt lgkmcnt(4)
  v_mfma_f32_32x32x16_bf16 v[38:53], a[224:227], v[154:157], v[38:53]
  ds_read_b128 a[248:251], v237 offset:63488
  buffer_load_dwordx4 v[214:217], v254, s[44:47], s12 offen offset:1024 sc1
  s_waitcnt vmcnt(15)
  v_mfma_f32_32x32x16_bf16 v[6:21], a[228:231], v[158:161], v[6:21]
  ds_read_b128 a[252:255], v237 offset:64512
  s_waitcnt lgkmcnt(5)
  s_barrier
  s_waitcnt lgkmcnt(4)
  v_mfma_f32_32x32x16_bf16 v[22:37], a[232:235], v[158:161], v[22:37]
  ds_read_b128 a[224:227], v236 offset:0
  buffer_load_dwordx4 v[218:221], v254, s[44:47], s12 offen offset:2048 sc1
  v_mfma_f32_32x32x16_bf16 v[38:53], a[236:239], v[158:161], v[38:53]
  ds_read_b128 a[228:231], v236 offset:1024
  s_waitcnt vmcnt(12)
  ds_read_b64_tr_b16 a[80:81], v244 offset:0
  ds_read_b64_tr_b16 a[82:83], v244 offset:1024
  ds_read_b64_tr_b16 a[84:85], v243 offset:0
  ds_read_b64_tr_b16 a[86:87], v243 offset:1024
  s_waitcnt lgkmcnt(8)
  v_mfma_f32_32x32x16_bf16 v[6:21], a[240:243], v[162:165], v[6:21]
  ds_read_b128 a[232:235], v236 offset:2048
  buffer_load_dwordx4 v[222:225], v254, s[44:47], s12 offen offset:3072 sc1
  s_waitcnt vmcnt(6)
  v_add_f32 v70, v70, v78
  v_mfma_f32_32x32x16_bf16 v[22:37], a[244:247], v[162:165], v[22:37]
  ds_read_b128 a[236:239], v236 offset:3072
  v_add_f32 v71, v71, v79
  v_add_f32 v72, v72, v80
  v_add_f32 v73, v73, v81
  v_add_f32 v74, v74, v82
  s_waitcnt lgkmcnt(8)
  v_mfma_f32_32x32x16_bf16 v[38:53], a[248:251], v[162:165], v[38:53]
  ds_read_b128 a[240:243], v236 offset:4096
  buffer_load_dwordx4 v[186:189], v254, s[44:47], s8 offen offset:2048 sc1
  v_add_f32 v75, v75, v83
  v_add_f32 v76, v76, v84
  v_mfma_f32_32x32x16_bf16 v[6:21], a[252:255], v[166:169], v[6:21]
  ds_read_b128 a[244:247], v236 offset:5120
  v_add_f32 v77, v77, v85
  v_add_f32 v70, v70, v74
  v_add_f32 v71, v71, v75
  v_add_f32 v72, v72, v76
  s_waitcnt lgkmcnt(8)
  v_mfma_f32_32x32x16_bf16 v[22:37], a[224:227], v[166:169], v[22:37]
  ds_read_b128 a[248:251], v236 offset:6144
  buffer_load_dwordx4 v[190:193], v254, s[44:47], s8 offen offset:3072 sc1
  v_add_f32 v73, v73, v77
  v_mfma_f32_32x32x16_bf16 v[38:53], a[228:231], v[166:169], v[38:53]
  ds_read_b128 a[252:255], v236 offset:7168
  v_permlane32_swap_b32 v70, v72
  v_permlane32_swap_b32 v71, v73
  v_add_f32 v70, v70, v72
  v_add_f32 v71, v71, v73
  s_waitcnt lgkmcnt(4)
  v_mfma_f32_32x32x16_bf16 v[6:21], a[232:235], v[170:173], v[6:21]
  ds_read_b128 a[224:227], v236 offset:8192
  s_add_u32 s8, s8, 4096
  buffer_load_dwordx4 v[194:197], v254, s[44:47], s8 offen offset:0 sc1
  v_cvt_pk_bf16_f32 v75, v70, v71
  v_lshlrev_b32 v72, 16, v75
  v_mfma_f32_32x32x16_bf16 v[22:37], a[236:239], v[170:173], v[22:37]
  ds_read_b128 a[228:231], v236 offset:9216
  v_and_b32 v73, s70, v75
  v_sub_f32 v70, v70, v72
  v_sub_f32 v71, v71, v73
  v_cvt_pk_bf16_f32 v74, v72, v70
  s_waitcnt lgkmcnt(4)
  v_mfma_f32_32x32x16_bf16 v[38:53], a[240:243], v[170:173], v[38:53]
  ds_read_b128 a[232:235], v236 offset:10240
  buffer_load_dwordx4 v[198:201], v254, s[44:47], s8 offen offset:1024 sc1
  v_cvt_pk_bf16_f32 v76, v71, v73
  v_mov_b32 v77, 0
  v_mfma_f32_32x32x16_bf16 v[6:21], a[244:247], v[174:177], v[6:21]
  ds_read_b128 a[236:239], v236 offset:11264
  ds_write_b128 v231, v[74:77]
  s_waitcnt lgkmcnt(5)
  v_mfma_f32_32x32x16_bf16 v[22:37], a[248:251], v[174:177], v[22:37]
  ds_read_b128 a[240:243], v236 offset:12288
  buffer_load_dwordx4 v[202:205], v254, s[44:47], s8 offen offset:2048 sc1
  v_mfma_f32_32x32x16_bf16 v[38:53], a[252:255], v[174:177], v[38:53]
  ds_read_b128 a[244:247], v236 offset:13312
  s_waitcnt vmcnt(5)
chk_29:
  v_min3_u32 v241, v253, v211, v213
  v_max3_u32 v240, v253, v211, v213
  v_min3_u32 v241, v241, v215, v217
  v_max3_u32 v240, v240, v215, v217
  v_min3_u32 v241, v241, v219, v221
  v_max3_u32 v240, v240, v219, v221
  v_min3_u32 v241, v241, v223, v225
  v_max3_u32 v240, v240, v223, v225
  v_cmp_ne_u32 vcc, v241, v240
  s_nop 4
  s_cbranch_vccz ok_31
slow_30:
  s_add_u32 s58, s58, 1
  s_cmp_gt_u32 s58, 200000
  s_cbranch_scc1 ok_31
  buffer_load_dwordx4 v[210:213], v254, s[44:47], s12 offen offset:0 sc1
  buffer_load_dwordx4 v[214:217], v254, s[44:47], s12 offen offset:1024 sc1
  buffer_load_dwordx4 v[218:221], v254, s[44:47], s12 offen offset:2048 sc1
  buffer_load_dwordx4 v[222:225], v254, s[44:47], s12 offen offset:3072 sc1
  s_waitcnt vmcnt(0)
  s_branch chk_29
ok_31:
  s_waitcnt lgkmcnt(5)
  v_mfma_f32_32x32x16_bf16 v[6:21], a[224:227], v[178:181], v[6:21]
  ds_read_b128 a[248:251], v236 offset:14336
  buffer_load_dwordx4 v[206:209], v254, s[44:47], s8 offen offset:3072 sc1
  v_mfma_f32_32x32x16_bf16 v[22:37], a[228:231], v[178:181], v[22:37]
  ds_read_b128 a[252:255], v236 offset:15360
  v_add_f32 v210, v210, v218
  v_add_f32 v212, v212, v220
  v_add_f32 v214, v214, v222
  s_waitcnt lgkmcnt(5)
  v_mfma_f32_32x32x16_bf16 v[38:53], a[232:235], v[178:181], v[38:53]
  ds_read_b128 a[224:227], v236 offset:16384
  s_add_u32 m0, s95, 0
  s_add_u32 s59, s94, 131072
  buffer_load_dwordx4 v254, s[44:47], s59 offen offset:0 sc1 lds
  v_add_f32 v216, v216, v224
  v_mfma_f32_32x32x16_bf16 v[6:21], a[236:239], v[182:185], v[6:21]
  ds_read_b128 a[228:231], v236 offset:17408
  v_add_f32 v218, v210, v214
  v_add_f32 v220, v212, v216
  v_mov_b32 v219, v218
  v_mov_b32 v221, v220
  s_waitcnt lgkmcnt(4)
  v_mfma_f32_32x32x16_bf16 v[22:37], a[240:243], v[182:185], v[22:37]
  ds_read_b128 a[232:235], v236 offset:18432
  s_add_u32 m0, s95, 0
  s_add_u32 s59, s94, 131072
  buffer_load_dwordx4 v254, s[44:47], s59 offen offset:1024 sc1 lds
  v_mfma_f32_32x32x16_bf16 v[38:53], a[244:247], v[182:185], v[38:53]
  ds_read_b128 a[236:239], v236 offset:19456
  v_permlane32_swap_b32 v218, v219
  v_permlane32_swap_b32 v220, v221
  v_add_f32 v218, v218, v219
  v_add_f32 v220, v220, v221
  s_waitcnt vmcnt(7) lgkmcnt(4)
  v_mfma_f32_32x32x16_bf16 v[6:21], a[248:251], v[186:189], v[6:21]
  ds_read_b128 a[240:243], v236 offset:20480
  s_add_u32 m0, s95, 0
  s_add_u32 s59, s94, 131072
  buffer_load_dwordx4 v254, s[44:47], s59 offen offset:2048 sc1 lds
  v_mul_f32 v219, 0xbb000000, v218
  v_mfma_f32_32x32x16_bf16 v[22:37], a[252:255], v[186:189], v[22:37]
  ds_read_b128 a[244:247], v236 offset:21504
  v_mul_f32 v220, 0x3b000000, v220
  v_fma_f32 v221, -v219, v219, v220
  v_max_f32 v221, 0, v221
  v_add_f32 v221, 0x3727c5ac, v221
  s_waitcnt lgkmcnt(4)
  v_mfma_f32_32x32x16_bf16 v[38:53], a[224:227], v[186:189], v[38:53]
  ds_read_b128 a[248:251], v236 offset:22528
  s_add_u32 m0, s95, 0
  s_add_u32 s59, s94, 131072
  buffer_load_dwordx4 v254, s[44:47], s59 offen offset:3072 sc1 lds
  v_sqrt_f32 v220, v221
  s_waitcnt vmcnt(8)
  v_mfma_f32_32x32x16_bf16 v[6:21], a[228:231], v[190:193], v[6:21]
  ds_read_b128 a[252:255], v236 offset:23552
  v_rcp_f32 v239, v221
  v_cmp_eq_u32 vcc, 0, v252
  v_mov_b32 v213, 0
  s_nop 0
  v_cndmask_b32 v219, 0, v219, vcc
  s_waitcnt lgkmcnt(4)
  v_mfma_f32_32x32x16_bf16 v[22:37], a[232:235], v[190:193], v[22:37]
  ds_read_b128 a[224:227], v236 offset:24576
  s_add_u32 m0, s95, 16384
  s_add_u32 s59, s94, 147456
  buffer_load_dwordx4 v254, s[44:47], s59 offen offset:0 sc1 lds
  v_cndmask_b32 v220, 0, v220, vcc
  v_mfma_f32_32x32x16_bf16 v[38:53], a[236:239], v[190:193], v[38:53]
  ds_read_b128 a[228:231], v236 offset:25600
  v_cvt_pk_bf16_f32 v210, v219, v219
  v_cvt_pk_bf16_f32 v222, v220, v220
  v_and_b32 v218, s70, v210
  v_and_b32 v222, s70, v222
  s_waitcnt vmcnt(8) lgkmcnt(4)
  v_mfma_f32_32x32x16_bf16 v[6:21], a[240:243], v[194:197], v[6:21]
  ds_read_b128 a[232:235], v236 offset:26624
  s_add_u32 m0, s95, 16384
  s_add_u32 s59, s94, 147456
  buffer_load_dwordx4 v254, s[44:47], s59 offen offset:1024 sc1 lds
  v_sub_f32 v219, v219, v218
  v_mfma_f32_32x32x16_bf16 v[22:37], a[244:247], v[194:197], v[22:37]
  ds_read_b128 a[236:239], v236 offset:27648
  v_sub_f32 v220, v220, v222
  v_cvt_pk_bf16_f32 v211, v219, v222
  v_cvt_pk_bf16_f32 v212, v222, v220
  s_waitcnt lgkmcnt(4)
  v_mfma_f32_32x32x16_bf16 v[38:53], a[248:251], v[194:197], v[38:53]
  ds_read_b128 a[240:243], v236 offset:28672
  s_add_u32 m0, s95, 16384
  s_add_u32 s59, s94, 147456
  buffer_load_dwordx4 v254, s[44:47], s59 offen offset:2048 sc1 lds
  s_waitcnt vmcnt(9)
  v_mfma_f32_32x32x16_bf16 v[6:21], a[252:255], v[198:201], v[6:21]
  ds_read_b128 a[244:247], v236 offset:29696
  s_waitcnt lgkmcnt(4)
  v_mfma_f32_32x32x16_bf16 v[22:37], a[224:227], v[198:201], v[22:37]
  ds_read_b128 a[248:251], v236 offset:30720
  s_add_u32 m0, s95, 16384
  s_add_u32 s59, s94, 147456
  buffer_load_dwordx4 v254, s[44:47], s59 offen offset:3072 sc1 lds
  s_barrier
  v_mfma_f32_32x32x16_bf16 v[38:53], a[228:231], v[198:201], v[38:53]
  ds_read_b128 a[252:255], v236 offset:31744
  s_waitcnt vmcnt(9) lgkmcnt(4)
  v_mfma_f32_32x32x16_bf16 v[6:21], a[232:235], v[202:205], v[6:21]
  ds_read_b128 a[224:227], v236 offset:32768
  s_add_u32 m0, s95, 32768
  s_add_u32 s59, s94, 163840
  buffer_load_dwordx4 v254, s[44:47], s59 offen offset:0 sc1 lds
  v_mfma_f32_32x32x16_bf16 v[22:37], a[236:239], v[202:205], v[22:37]
  ds_read_b128 a[228:231], v235 offset:0
  s_waitcnt lgkmcnt(4)
  v_mfma_f32_32x32x16_bf16 v[38:53], a[240:243], v[202:205], v[38:53]
  ds_read_b128 a[232:235], v235 offset:512
  s_add_u32 m0, s95, 32768
  s_add_u32 s59, s94, 163840
  buffer_load_dwordx4 v254, s[44:47], s59 offen offset:1024 sc1 lds
  s_waitcnt vmcnt(10)
  v_mfma_f32_32x32x16_bf16 v[6:21], a[244:247], v[206:209], v[6:21]
  ds_read_b128 a[236:239], v235 offset:1024
  s_waitcnt lgkmcnt(4)
  v_mfma_f32_32x32x16_bf16 v[22:37], a[248:251], v[206:209], v[22:37]
  ds_read_b128 a[240:243], v235 offset:1536
  s_add_u32 m0, s95, 32768
  s_add_u32 s59, s94, 163840
  buffer_load_dwordx4 v254, s[44:47], s59 offen offset:2048 sc1 lds
  v_mfma_f32_32x32x16_bf16 v[38:53], a[252:255], v[206:209], v[38:53]
  ds_read_b128 a[244:247], v236 offset:33792
  s_waitcnt lgkmcnt(4)
  v_mfma_f32_32x32x16_bf16 v[54:69], a[224:227], v[2:5], 0
  ds_read_b128 a[248:251], v236 offset:34816
  s_add_u32 m0, s95, 32768
  s_add_u32 s59, s94, 163840
  buffer_load_dwordx4 v254, s[44:47], s59 offen offset:3072 sc1 lds
  v_mfma_f32_32x32x16_bf16 v[6:21], a[228:231], v[210:213], v[6:21]
  ds_read_b128 a[252:255], v236 offset:35840
  s_waitcnt lgkmcnt(4)
  v_mfma_f32_32x32x16_bf16 v[22:37], a[232:235], v[210:213], v[22:37]
  ds_read_b128 a[224:227], v236 offset:36864
  s_add_u32 m0, s95, 49152
  s_add_u32 s59, s94, 180224
  buffer_load_dwordx4 v254, s[44:47], s59 offen offset:0 sc1 lds
  v_mfma_f32_32x32x16_bf16 v[38:53], a[236:239], v[210:213], v[38:53]
  ds_read_b128 a[228:231], v236 offset:37888
  s_waitcnt lgkmcnt(4)
  v_mfma_f32_32x32x16_bf16 v[54:69], a[240:243], v[210:213], v[54:69]
  ds_read_b128 a[232:235], v236 offset:38912
  s_add_u32 m0, s95, 49152
  s_add_u32 s59, s94, 180224
  buffer_load_dwordx4 v254, s[44:47], s59 offen offset:1024 sc1 lds
  v_mfma_f32_32x32x16_bf16 v[54:69], a[244:247], v[86:89], v[54:69]
  ds_read_b128 a[236:239], v236 offset:39936
  v_mul_f32 v6, v6, v14
  v_mul_f32 v7, v7, v15
  v_mul_f32 v8, v8, v16
  v_mul_f32 v9, v9, v17
  s_waitcnt lgkmcnt(4)
  v_mfma_f32_32x32x16_bf16 v[54:69], a[248:251], v[90:93], v[54:69]
  ds_read_b128 a[240:243], v236 offset:40960
  s_add_u32 m0, s95, 49152
  s_add_u32 s59, s94, 180224
  buffer_load_dwordx4 v254, s[44:47], s59 offen offset:2048 sc1 lds
  v_mul_f32 v10, v10, v18
  v_mfma_f32_32x32x16_bf16 v[54:69], a[252:255], v[94:97], v[54:69]
  ds_read_b128 a[244:247], v236 offset:41984
  v_mul_f32 v11, v11, v19
  v_mul_f32 v12, v12, v20
  v_mul_f32 v13, v13, v21
  v_mul_f32 v6, v6, v239
  s_waitcnt lgkmcnt(4)
  v_mfma_f32_32x32x16_bf16 v[54:69], a[224:227], v[98:101], v[54:69]
  ds_read_b128 a[248:251], v236 offset:43008
  s_add_u32 m0, s95, 49152
  s_add_u32 s59, s94, 180224
  buffer_load_dwordx4 v254, s[44:47], s59 offen offset:3072 sc1 lds
  v_mul_f32 v7, v7, v239
  v_mfma_f32_32x32x16_bf16 v[54:69], a[228:231], v[102:105], v[54:69]
  ds_read_b128 a[252:255], v236 offset:44032
  v_mul_f32 v8, v8, v239
  v_mul_f32 v9, v9, v239
  v_mul_f32 v10, v10, v239
  v_mul_f32 v11, v11, v239
  s_waitcnt lgkmcnt(5)
  s_barrier
  s_waitcnt lgkmcnt(4)
  v_mfma_f32_32x32x16_bf16 v[54:69], a[232:235], v[106:109], v[54:69]
  ds_read_b128 a[224:227], v236 offset:45056
  s_add_u32 m0, s95, 65536
  s_add_u32 s59, s94, 196608
  buffer_load_dwordx4 v254, s[44:47], s59 offen offset:0 sc1 lds
  v_mul_f32 v12, v12, v239
  v_mfma_f32_32x32x16_bf16 v[54:69], a[236:239], v[110:113], v[54:69]
  ds_read_b128 a[228:231], v236 offset:46080
  v_mul_f32 v13, v13, v239
  v_cvt_pk_bf16_f32 v214, v6, v7
  v_cvt_pk_bf16_f32 v215, v8, v9
  v_cvt_pk_bf16_f32 v216, v10, v11
  s_waitcnt lgkmcnt(4)
  v_mfma_f32_32x32x16_bf16 v[54:69], a[240:243], v[114:117], v[54:69]
  ds_read_b128 a[232:235], v236 offset:47104
  v_cvt_pk_bf16_f32 v217, v12, v13
  buffer_store_dwordx4 v[214:217], v254, s[44:47], s11 offen offset:0 sc0 sc1
  v_mfma_f32_32x32x16_bf16 v[54:69], a[244:247], v[118:121], v[54:69]
  ds_read_b128 a[236:239], v236 offset:48128
  s_waitcnt lgkmcnt(4)
  v_mfma_f32_32x32x16_bf16 v[54:69], a[248:251], v[122:125], v[54:69]
  ds_read_b128 a[240:243], v236 offset:49152
  s_add_u32 m0, s95, 65536
  s_add_u32 s59, s94, 196608
  buffer_load_dwordx4 v254, s[44:47], s59 offen offset:1024 sc1 lds
  v_mfma_f32_32x32x16_bf16 v[54:69], a[252:255], v[126:129], v[54:69]
  ds_read_b128 a[244:247], v236 offset:50176
  s_waitcnt lgkmcnt(4)
  v_mfma_f32_32x32x16_bf16 v[54:69], a[224:227], v[130:133], v[54:69]
  ds_read_b128 a[248:251], v236 offset:51200
  s_add_u32 m0, s95, 65536
  s_add_u32 s59, s94, 196608
  buffer_load_dwordx4 v254, s[44:47], s59 offen offset:2048 sc1 lds
  v_mfma_f32_32x32x16_bf16 v[54:69], a[228:231], v[134:137], v[54:69]
  ds_read_b128 a[252:255], v236 offset:52224
  v_mul_f32 v22, v22, v30
  s_waitcnt lgkmcnt(4)
  v_mfma_f32_32x32x16_bf16 v[54:69], a[232:235], v[138:141], v[54:69]
  ds_read_b128 a[224:227], v236 offset:53248
  s_add_u32 m0, s95, 65536
  s_add_u32 s59, s94, 196608
  buffer_load_dwordx4 v254, s[44:47], s59 offen offset:3072 sc1 lds
  v_mul_f32 v23, v23, v31
  v_mfma_f32_32x32x16_bf16 v[54:69], a[236:239], v[142:145], v[54:69]
  ds_read_b128 a[228:231], v236 offset:54272
  v_mul_f32 v24, v24, v32
  v_mul_f32 v25, v25, v33
  v_mul_f32 v26, v26, v34
  v_mul_f32 v27, v27, v35
  s_waitcnt lgkmcnt(4)
  v_mfma_f32_32x32x16_bf16 v[54:69], a[240:243], v[146:149], v[54:69]
  ds_read_b128 a[232:235], v236 offset:55296
  s_add_u32 m0, s95, 81920
  s_add_u32 s59, s94, 212992
  buffer_load_dwordx4 v254, s[44:47], s59 offen offset:0 sc1 lds
  v_mul_f32 v28, v28, v36
  v_mfma_f32_32x32x16_bf16 v[54:69], a[244:247], v[150:153], v[54:69]
  ds_read_b128 a[236:239], v236 offset:56320
  v_mul_f32 v29, v29, v37
  v_mul_f32 v22, v22, v239
  v_mul_f32 v23, v23, v239
  v_mul_f32 v24, v24, v239
  s_waitcnt lgkmcnt(4)
  v_mfma_f32_32x32x16_bf16 v[54:69], a[248:251], v[154:157], v[54:69]
  ds_read_b128 a[240:243], v236 offset:57344
  s_add_u32 m0, s95, 81920
  s_add_u32 s59, s94, 212992
  buffer_load_dwordx4 v254, s[44:47], s59 offen offset:1024 sc1 lds
  v_mul_f32 v25, v25, v239
  v_mfma_f32_32x32x16_bf16 v[54:69], a[252:255], v[158:161], v[54:69]
  ds_read_b128 a[244:247], v236 offset:58368
  v_mul_f32 v26, v26, v239
  v_mul_f32 v27, v27, v239
  v_mul_f32 v28, v28, v239
  v_mul_f32 v29, v29, v239
  s_waitcnt lgkmcnt(4)
  v_mfma_f32_32x32x16_bf16 v[54:69], a[224:227], v[162:165], v[54:69]
  ds_read_b128 a[248:251], v236 offset:59392
  s_add_u32 m0, s95, 81920
  s_add_u32 s59, s94, 212992
  buffer_load_dwordx4 v254, s[44:47], s59 offen offset:2048 sc1 lds
  v_cvt_pk_bf16_f32 v214, v22, v23
  v_mfma_f32_32x32x16_bf16 v[54:69], a[228:231], v[166:169], v[54:69]
  ds_read_b128 a[252:255], v236 offset:60416
  v_cvt_pk_bf16_f32 v215, v24, v25
  v_cvt_pk_bf16_f32 v216, v26, v27
  v_cvt_pk_bf16_f32 v217, v28, v29
  s_waitcnt lgkmcnt(4)
  v_mfma_f32_32x32x16_bf16 v[54:69], a[232:235], v[170:173], v[54:69]
  ds_read_b128 a[224:227], v236 offset:61440
  buffer_store_dwordx4 v[214:217], v254, s[44:47], s11 offen offset:1024 sc0 sc1
  v_mfma_f32_32x32x16_bf16 v[54:69], a[236:239], v[174:177], v[54:69]
  ds_read_b128 a[228:231], v236 offset:62464
  s_waitcnt lgkmcnt(4)
  v_mfma_f32_32x32x16_bf16 v[54:69], a[240:243], v[178:181], v[54:69]
  ds_read_b128 a[232:235], v236 offset:63488
  s_add_u32 m0, s95, 81920
  s_add_u32 s59, s94, 212992
  buffer_load_dwordx4 v254, s[44:47], s59 offen offset:3072 sc1 lds
  v_mfma_f32_32x32x16_bf16 v[54:69], a[244:247], v[182:185], v[54:69]
  ds_read_b128 a[236:239], v236 offset:64512
  s_waitcnt vmcnt(22) lgkmcnt(5)
  s_barrier
  s_sub_u32 s64, s95, s89
  s_add_u32 s64, s64, 98304
  v_add_u32 v238, s64, v244
  v_add_u32 v232, s64, v243
  s_waitcnt lgkmcnt(4)
  v_mfma_f32_32x32x16_bf16 v[54:69], a[248:251], v[186:189], v[54:69]
  ds_read_b128 a[240:243], v235 offset:2048
  s_add_u32 m0, s89, 2048
  s_nop 0
  buffer_load_dwordx4 v245, s[28:31], s83 offen offset:1024 lds
  v_mfma_f32_32x32x16_bf16 v[54:69], a[252:255], v[190:193], v[54:69]
  ds_read_b128 a[244:247], v237 offset:0
  v_mul_f32 v38, v38, v46
  s_waitcnt lgkmcnt(4)
  v_mfma_f32_32x32x16_bf16 v[54:69], a[224:227], v[194:197], v[54:69]
  ds_read_b128 a[248:251], v237 offset:1024
  s_add_u32 m0, s95, 98304
  s_add_u32 s83, s88, 49152
  buffer_load_dwordx4 v246, s[28:31], s83 offen lds
  v_mfma_f32_32x32x16_bf16 v[54:69], a[228:231], v[198:201], v[54:69]
  ds_read_b128 a[252:255], v237 offset:2048
  v_mul_f32 v39, v39, v47
  v_mul_f32 v40, v40, v48
  v_mul_f32 v41, v41, v49
  v_mul_f32 v42, v42, v50
  s_waitcnt lgkmcnt(4)
  v_mfma_f32_32x32x16_bf16 v[54:69], a[232:235], v[202:205], v[54:69]
  ds_read_b128 a[224:227], v237 offset:3072
  s_add_u32 m0, s95, 98304
  s_nop 0
  buffer_load_dwordx4 v245, s[28:31], s83 offen offset:1024 lds
  v_mfma_f32_32x32x16_bf16 v[54:69], a[236:239], v[206:209], v[54:69]
  ds_read_b128 a[228:231], v237 offset:4096
  v_mul_f32 v43, v43, v51
  v_mul_f32 v44, v44, v52
  v_mul_f32 v45, v45, v53
  v_mul_f32 v38, v38, v239
  s_waitcnt lgkmcnt(4)
  v_mfma_f32_32x32x16_bf16 v[70:85], a[240:243], v[210:213], 0
  ds_read_b128 a[232:235], v237 offset:5120
  s_add_u32 m0, s95, 100352
  s_add_u32 s83, s88, 65536
  buffer_load_dwordx4 v246, s[28:31], s83 offen lds
  v_mfma_f32_32x32x16_bf16 v[70:85], a[244:247], v[2:5], v[70:85]
  ds_read_b128 a[236:239], v237 offset:6144
  v_mul_f32 v39, v39, v239
  v_mul_f32 v40, v40, v239
  v_mul_f32 v41, v41, v239
  v_mul_f32 v42, v42, v239
  s_waitcnt lgkmcnt(4)
  v_mfma_f32_32x32x16_bf16 v[70:85], a[248:251], v[86:89], v[70:85]
  ds_read_b128 a[240:243], v237 offset:7168
  s_add_u32 m0, s95, 100352
  s_nop 0
  buffer_load_dwordx4 v245, s[28:31], s83 offen offset:1024 lds
  v_mfma_f32_32x32x16_bf16 v[70:85], a[252:255], v[90:93], v[70:85]
  ds_read_b128 a[244:247], v237 offset:8192
  v_mul_f32 v43, v43, v239
  v_mul_f32 v44, v44, v239
  v_mul_f32 v45, v45, v239
  v_cvt_pk_bf16_f32 v214, v38, v39
  s_waitcnt lgkmcnt(4)
  v_mfma_f32_32x32x16_bf16 v[70:85], a[224:227], v[94:97], v[70:85]
  ds_read_b128 a[248:251], v237 offset:9216
  s_add_u32 m0, s89, 4096
  s_add_u32 s83, s88, 163840
  buffer_load_dwordx4 v246, s[28:31], s83 offen lds
  v_mfma_f32_32x32x16_bf16 v[70:85], a[228:231], v[98:101], v[70:85]
  ds_read_b128 a[252:255], v237 offset:10240
  v_cvt_pk_bf16_f32 v215, v40, v41
  v_cvt_pk_bf16_f32 v216, v42, v43
  v_cvt_pk_bf16_f32 v217, v44, v45
  s_waitcnt lgkmcnt(4)
  v_mfma_f32_32x32x16_bf16 v[70:85], a[232:235], v[102:105], v[70:85]
  ds_read_b128 a[224:227], v237 offset:11264
  buffer_store_dwordx4 v[214:217], v254, s[44:47], s11 offen offset:2048 sc0 sc1
  v_mfma_f32_32x32x16_bf16 v[70:85], a[236:239], v[106:109], v[70:85]
  ds_read_b128 a[228:231], v237 offset:12288
  s_waitcnt lgkmcnt(4)
  v_mfma_f32_32x32x16_bf16 v[70:85], a[240:243], v[110:113], v[70:85]
  ds_read_b128 a[232:235], v237 offset:13312
  s_add_u32 m0, s89, 4096
  s_nop 0
  buffer_load_dwordx4 v245, s[28:31], s83 offen offset:1024 lds
  v_mfma_f32_32x32x16_bf16 v[70:85], a[244:247], v[114:117], v[70:85]
  ds_read_b128 a[236:239], v237 offset:14336
  s_waitcnt vmcnt(26) lgkmcnt(5)
  s_barrier
  s_waitcnt lgkmcnt(4)
  v_mfma_f32_32x32x16_bf16 v[70:85], a[248:251], v[118:121], v[70:85]
  ds_read_b128 a[240:243], v237 offset:15360
  s_add_u32 m0, s95, 114688
  s_add_u32 s83, s88, 180224
  buffer_load_dwordx4 v246, s[28:31], s83 offen lds
  v_mfma_f32_32x32x16_bf16 v[70:85], a[252:255], v[122:125], v[70:85]
  ds_read_b128 a[244:247], v237 offset:16384
  s_waitcnt lgkmcnt(4)
  v_mfma_f32_32x32x16_bf16 v[70:85], a[224:227], v[126:129], v[70:85]
  ds_read_b128 a[248:251], v237 offset:17408
  s_add_u32 m0, s95, 114688
  s_nop 0
  buffer_load_dwordx4 v245, s[28:31], s83 offen offset:1024 lds
  v_mfma_f32_32x32x16_bf16 v[70:85], a[228:231], v[130:133], v[70:85]
  ds_read_b128 a[252:255], v237 offset:18432
  v_mul_f32 v54, v54, v62
  v_mul_f32 v55, v55, v63
  v_mul_f32 v56, v56, v64
  v_mul_f32 v57, v57, v65
  s_waitcnt lgkmcnt(4)
  v_mfma_f32_32x32x16_bf16 v[70:85], a[232:235], v[134:137], v[70:85]
  ds_read_b128 a[224:227], v237 offset:19456
  s_add_u32 m0, s95, 116736
  s_add_u32 s83, s88, 278528
  buffer_load_dwordx4 v246, s[28:31], s83 offen lds
  v_mfma_f32_32x32x16_bf16 v[70:85], a[236:239], v[138:141], v[70:85]
  ds_read_b128 a[228:231], v237 offset:20480
  v_mul_f32 v58, v58, v66
  v_mul_f32 v59, v59, v67
  v_mul_f32 v60, v60, v68
  v_mul_f32 v61, v61, v69
  s_waitcnt lgkmcnt(4)
  v_mfma_f32_32x32x16_bf16 v[70:85], a[240:243], v[142:145], v[70:85]
  ds_read_b128 a[232:235], v237 offset:21504
  s_add_u32 m0, s95, 116736
  s_nop 0
  buffer_load_dwordx4 v245, s[28:31], s83 offen offset:1024 lds
  v_mfma_f32_32x32x16_bf16 v[70:85], a[244:247], v[146:149], v[70:85]
  ds_read_b128 a[236:239], v237 offset:22528
  v_mul_f32 v54, v54, v239
  v_mul_f32 v55, v55, v239
  v_mul_f32 v56, v56, v239
  v_mul_f32 v57, v57, v239
  s_waitcnt lgkmcnt(4)
  v_mfma_f32_32x32x16_bf16 v[70:85], a[248:251], v[150:153], v[70:85]
  ds_read_b128 a[240:243], v237 offset:23552
  s_add_u32 m0, s89, 0
  s_add_u32 s83, s88, 294912
  buffer_load_dwordx4 v246, s[28:31], s83 offen lds
  v_mfma_f32_32x32x16_bf16 v[70:85], a[252:255], v[154:157], v[70:85]
  ds_read_b128 a[244:247], v237 offset:24576
  v_mul_f32 v58, v58, v239
  v_mul_f32 v59, v59, v239
  v_mul_f32 v60, v60, v239
  v_mul_f32 v61, v61, v239
  s_waitcnt lgkmcnt(4)
  v_mfma_f32_32x32x16_bf16 v[70:85], a[224:227], v[158:161], v[70:85]
  ds_read_b128 a[248:251], v237 offset:25600
  s_waitcnt vmcnt(6)
  s_mov_b32 s65, 393216
  buffer_store_dword v253, v233, s[44:47], s65 offen sc1
  v_cvt_pk_bf16_f32 v214, v54, v55
  v_cvt_pk_bf16_f32 v215, v56, v57
  v_mfma_f32_32x32x16_bf16 v[70:85], a[228:231], v[162:165], v[70:85]
  ds_read_b128 a[252:255], v237 offset:26624
  ds_read_b64_tr_b16 a[88:89], v244 offset:2048
  ds_read_b64_tr_b16 a[90:91], v244 offset:3072
  ds_read_b64_tr_b16 a[92:93], v243 offset:2048
  ds_read_b64_tr_b16 a[94:95], v243 offset:3072
  s_waitcnt lgkmcnt(8)
  v_mfma_f32_32x32x16_bf16 v[70:85], a[232:235], v[166:169], v[70:85]
  ds_read_b128 a[224:227], v237 offset:27648
  ds_read_b64_tr_b16 a[96:97], v238 offset:0
  ds_read_b64_tr_b16 a[98:99], v238 offset:1024
  ds_read_b64_tr_b16 a[100:101], v232 offset:0
  ds_read_b64_tr_b16 a[102:103], v232 offset:1024
  v_mfma_f32_32x32x16_bf16 v[70:85], a[236:239], v[170:173], v[70:85]
  s_branch L_pskip2
.p2align 12
L_pstub2:
  s_branch L_pback2
L_pskip2:
  ds_read_b128 a[228:231], v237 offset:28672
  v_cvt_pk_bf16_f32 v216, v58, v59
  v_cvt_pk_bf16_f32 v217, v60, v61
  buffer_store_dwordx4 v[214:217], v254, s[44:47], s11 offen offset:3072 sc0 sc1
  s_waitcnt lgkmcnt(12)
  v_mfma_f32_32x32x16_bf16 v[70:85], a[240:243], v[174:177], v[70:85]
  ds_read_b128 a[232:235], v237 offset:29696
  s_lshr_b32 s62, s57, 1
  s_lshl_b32 s14, s86, 1
  s_add_u32 s14, s14, s62
  s_mul_i32 s63, s57, 28
  v_mfma_f32_32x32x16_bf16 v[70:85], a[244:247], v[178:181], v[70:85]
  ds_read_b128 a[236:239], v237 offset:30720
  s_add_u32 m0, s89, 0
  s_nop 0
  buffer_load_dwordx4 v245, s[28:31], s83 offen offset:1024 lds
  s_waitcnt lgkmcnt(12)
  v_mfma_f32_32x32x16_bf16 v[70:85], a[248:251], v[182:185], v[70:85]
  ds_read_b128 a[240:243], v237 offset:31744
  ds_read_b64_tr_b16 a[104:105], v238 offset:2048
  ds_read_b64_tr_b16 a[106:107], v238 offset:3072
  ds_read_b64_tr_b16 a[108:109], v232 offset:2048
  ds_read_b64_tr_b16 a[110:111], v232 offset:3072
  s_barrier
  v_mfma_f32_32x32x16_bf16 v[70:85], a[252:255], v[186:189], v[70:85]
  ds_read_b128 a[244:247], v235 offset:2560
  s_waitcnt lgkmcnt(14)
  s_add_u32 m0, s89, 2048
  s_add_u32 s83, s88, 393216
  buffer_load_dwordx4 v246, s[28:31], s83 offen lds
  s_waitcnt lgkmcnt(8)
  v_mfma_f32_32x32x16_bf16 v[70:85], a[224:227], v[190:193], v[70:85]
  ds_read_b128 a[248:251], v237 offset:32768
  s_mul_i32 s15, s14, 112
  s_add_u32 s15, s15, s63
  s_lshl_b32 s15, s15, 10
  s_add_u32 s15, s15, 17825792
  v_mfma_f32_32x32x16_bf16 v[70:85], a[228:231], v[194:197], v[70:85]
  ds_read_b128 a[252:255], v237 offset:33792
  s_add_u32 m0, s89, 2048
  s_nop 0
  buffer_load_dwordx4 v245, s[28:31], s83 offen offset:1024 lds
  s_waitcnt lgkmcnt(8)
  v_mfma_f32_32x32x16_bf16 v[70:85], a[232:235], v[198:201], v[70:85]
  ds_read_b128 a[224:227], v237 offset:34816
  s_xor_b32 s62, s14, 1
  s_mul_i32 s16, s62, 112
  s_add_u32 s16, s16, s63
  s_lshl_b32 s16, s16, 10
  v_mfma_f32_32x32x16_bf16 v[70:85], a[236:239], v[202:205], v[70:85]
  ds_read_b128 a[228:231], v237 offset:35840
  s_add_u32 m0, s95, 98304
  s_add_u32 s83, s88, 409600
  buffer_load_dwordx4 v246, s[28:31], s83 offen lds
  s_waitcnt lgkmcnt(4)
  v_mfma_f32_32x32x16_bf16 v[70:85], a[240:243], v[206:209], v[70:85]
  ds_read_b128 a[232:235], v237 offset:36864
  s_add_u32 s16, s16, 17825792
  v_and_b32 v248, 1, v255
  v_lshlrev_b32 v248, 4, v248
  v_bfe_u32 v247, v255, 1, 2
  v_mfma_f32_32x32x16_bf16 v[6:21], a[244:247], v[210:213], 0
  ds_read_b128 a[236:239], v237 offset:37888
  s_add_u32 m0, s95, 98304
  s_nop 0
  buffer_load_dwordx4 v245, s[28:31], s83 offen offset:1024 lds
  s_waitcnt lgkmcnt(4)
  v_mfma_f32_32x32x16_bf16 v[6:21], a[248:251], v[2:5], v[6:21]
  ds_read_b128 a[240:243], v237 offset:38912
  v_add_u32 v248, v248, v247
  s_lshl_b32 s62, s86, 5
  s_lshl_b32 s63, s57, 2
  s_add_u32 s62, s62, s63
  v_mfma_f32_32x32x16_bf16 v[6:21], a[252:255], v[86:89], v[6:21]
  ds_read_b128 a[244:247], v237 offset:39936
  s_add_u32 m0, s95, 100352
  s_add_u32 s83, s88, 81920
  buffer_load_dwordx4 v246, s[28:31], s83 offen lds
  s_waitcnt lgkmcnt(4)
  v_mfma_f32_32x32x16_bf16 v[6:21], a[224:227], v[90:93], v[6:21]
  ds_read_b128 a[248:251], v237 offset:40960
  s_waitcnt vmcnt(13)
  ds_read_b64_tr_b16 a[112:113], v244 offset:4096
  ds_read_b64_tr_b16 a[114:115], v244 offset:5120
  ds_read_b64_tr_b16 a[116:117], v243 offset:4096
  ds_read_b64_tr_b16 a[118:119], v243 offset:5120
  v_mfma_f32_32x32x16_bf16 v[6:21], a[228:231], v[94:97], v[6:21]
  ds_read_b128 a[252:255], v237 offset:41984
  s_add_u32 m0, s95, 100352
  s_nop 0
  buffer_load_dwordx4 v245, s[28:31], s83 offen offset:1024 lds
  s_waitcnt lgkmcnt(8)
  v_mfma_f32_32x32x16_bf16 v[6:21], a[232:235], v[98:101], v[6:21]
  ds_read_b128 a[224:227], v237 offset:43008
  s_waitcnt vmcnt(12)
  ds_read_b64_tr_b16 a[120:121], v238 offset:16384
  ds_read_b64_tr_b16 a[122:123], v238 offset:17408
  ds_read_b64_tr_b16 a[124:125], v232 offset:16384
  ds_read_b64_tr_b16 a[126:127], v232 offset:17408
  v_mfma_f32_32x32x16_bf16 v[6:21], a[236:239], v[102:105], v[6:21]
  ds_read_b128 a[228:231], v237 offset:44032
  s_waitcnt lgkmcnt(7)
  s_add_u32 m0, s89, 4096
  s_add_u32 s83, s88, 196608
  buffer_load_dwordx4 v246, s[28:31], s83 offen lds
  v_mfma_f32_32x32x16_bf16 v[6:21], a[240:243], v[106:109], v[6:21]
  ds_read_b128 a[232:235], v237 offset:45056
  s_waitcnt vmcnt(11)
  ds_read_b64_tr_b16 a[128:129], v238 offset:18432
  ds_read_b64_tr_b16 a[130:131], v238 offset:19456
  ds_read_b64_tr_b16 a[132:133], v232 offset:18432
  ds_read_b64_tr_b16 a[134:135], v232 offset:19456
  v_mfma_f32_32x32x16_bf16 v[6:21], a[244:247], v[110:113], v[6:21]
  ds_read_b128 a[236:239], v237 offset:46080
  s_add_u32 m0, s89, 4096
  s_nop 0
  buffer_load_dwordx4 v245, s[28:31], s83 offen offset:1024 lds
  s_waitcnt lgkmcnt(12)
  v_mfma_f32_32x32x16_bf16 v[6:21], a[248:251], v[114:117], v[6:21]
  ds_read_b128 a[240:243], v237 offset:47104
  v_add_lshl_u32 v241, v248, s62, 5
  v_mul_f32 v70, v70, v78
  v_mul_f32 v71, v71, v79
  v_mul_f32 v72, v72, v80
  v_mfma_f32_32x32x16_bf16 v[6:21], a[252:255], v[118:121], v[6:21]
  ds_read_b128 a[244:247], v237 offset:48128
  s_waitcnt lgkmcnt(9)
  s_add_u32 m0, s95, 114688
  s_add_u32 s83, s88, 311296
  buffer_load_dwordx4 v246, s[28:31], s83 offen lds
  s_waitcnt lgkmcnt(8)
  v_mfma_f32_32x32x16_bf16 v[6:21], a[224:227], v[122:125], v[6:21]
  ds_read_b128 a[248:251], v237 offset:49152
  v_mul_f32 v73, v73, v81
  v_mul_f32 v74, v74, v82
  v_mul_f32 v75, v75, v83
  v_mul_f32 v76, v76, v84
  v_mfma_f32_32x32x16_bf16 v[6:21], a[228:231], v[126:129], v[6:21]
  ds_read_b128 a[252:255], v237 offset:50176
  s_add_u32 m0, s95, 114688
  s_nop 0
  buffer_load_dwordx4 v245, s[28:31], s83 offen offset:1024 lds
  s_waitcnt lgkmcnt(4)
  v_mfma_f32_32x32x16_bf16 v[6:21], a[232:235], v[130:133], v[6:21]
  ds_read_b128 a[224:227], v237 offset:51200
  v_mul_f32 v77, v77, v85
  v_mul_f32 v70, v70, v239
  v_mul_f32 v71, v71, v239
  v_mul_f32 v72, v72, v239
  v_mfma_f32_32x32x16_bf16 v[6:21], a[236:239], v[134:137], v[6:21]
  ds_read_b128 a[228:231], v237 offset:52224
  s_add_u32 m0, s95, 116736
  s_add_u32 s83, s88, 425984
  buffer_load_dwordx4 v246, s[28:31], s83 offen lds
  s_waitcnt lgkmcnt(4)
  v_mfma_f32_32x32x16_bf16 v[6:21], a[240:243], v[138:141], v[6:21]
  ds_read_b128 a[232:235], v237 offset:53248
  v_mul_f32 v73, v73, v239
  v_mul_f32 v74, v74, v239
  v_mul_f32 v75, v75, v239
  v_mul_f32 v76, v76, v239
  v_mfma_f32_32x32x16_bf16 v[6:21], a[244:247], v[142:145], v[6:21]
  ds_read_b128 a[236:239], v237 offset:54272
  s_add_u32 m0, s95, 116736
  s_nop 0
  buffer_load_dwordx4 v245, s[28:31], s83 offen offset:1024 lds
  s_waitcnt lgkmcnt(4)
  v_mfma_f32_32x32x16_bf16 v[6:21], a[248:251], v[146:149], v[6:21]
  ds_read_b128 a[240:243], v237 offset:55296
  v_mul_f32 v77, v77, v239
  v_cvt_pk_bf16_f32 v214, v70, v71
  v_cvt_pk_bf16_f32 v215, v72, v73
  v_cvt_pk_bf16_f32 v216, v74, v75
  v_mfma_f32_32x32x16_bf16 v[6:21], a[252:255], v[150:153], v[6:21]
  ds_read_b128 a[244:247], v237 offset:56320
  v_cvt_pk_bf16_f32 v217, v76, v77
  buffer_store_dwordx4 v[214:217], v234, s[44:47], s11 offen offset:0 sc0 sc1
  s_waitcnt lgkmcnt(4)
  v_mfma_f32_32x32x16_bf16 v[6:21], a[224:227], v[154:157], v[6:21]
  ds_read_b128 a[248:251], v237 offset:57344
  v_mfma_f32_32x32x16_bf16 v[6:21], a[228:231], v[158:161], v[6:21]
  ds_read_b128 a[252:255], v237 offset:58368
  s_waitcnt vmcnt(13)
  ds_read_b64_tr_b16 a[136:137], v244 offset:0
  ds_read_b64_tr_b16 a[138:139], v244 offset:1024
  ds_read_b64_tr_b16 a[140:141], v243 offset:0
  ds_read_b64_tr_b16 a[142:143], v243 offset:1024
  s_waitcnt lgkmcnt(8)
  v_mfma_f32_32x32x16_bf16 v[6:21], a[232:235], v[162:165], v[6:21]
  ds_read_b128 a[224:227], v237 offset:59392
  s_waitcnt lgkmcnt(1)
  s_add_u32 m0, s89, 0
  s_add_u32 s83, s88, 98304
  buffer_load_dwordx4 v246, s[28:31], s83 offen lds
  v_mfma_f32_32x32x16_bf16 v[6:21], a[236:239], v[166:169], v[6:21]
  ds_read_b128 a[228:231], v237 offset:60416
  s_waitcnt vmcnt(12)
  ds_read_b64_tr_b16 a[144:145], v244 offset:2048
  ds_read_b64_tr_b16 a[146:147], v244 offset:3072
  ds_read_b64_tr_b16 a[148:149], v243 offset:2048
  ds_read_b64_tr_b16 a[150:151], v243 offset:3072
  v_mfma_f32_32x32x16_bf16 v[6:21], a[240:243], v[170:173], v[6:21]
  ds_read_b128 a[232:235], v237 offset:61440
  s_add_u32 m0, s89, 0
  s_nop 0
  buffer_load_dwordx4 v245, s[28:31], s83 offen offset:1024 lds
  v_mfma_f32_32x32x16_bf16 v[6:21], a[244:247], v[174:177], v[6:21]
  ds_read_b128 a[236:239], v237 offset:62464
  s_waitcnt vmcnt(11)
  ds_read_b64_tr_b16 a[152:153], v238 offset:0
  ds_read_b64_tr_b16 a[154:155], v238 offset:1024
  ds_read_b64_tr_b16 a[156:157], v232 offset:0
  ds_read_b64_tr_b16 a[158:159], v232 offset:1024
  v_mfma_f32_32x32x16_bf16 v[6:21], a[248:251], v[178:181], v[6:21]
  ds_read_b128 a[240:243], v237 offset:63488
  s_waitcnt lgkmcnt(7)
  s_add_u32 m0, s89, 2048
  s_add_u32 s83, s88, 212992
  buffer_load_dwordx4 v246, s[28:31], s83 offen lds
  v_mfma_f32_32x32x16_bf16 v[6:21], a[252:255], v[182:185], v[6:21]
  ds_read_b128 a[244:247], v237 offset:64512
  v_mfma_f32_32x32x16_bf16 v[6:21], a[224:227], v[186:189], v[6:21]
  ds_read_b128 a[248:251], v235 offset:3072
  s_add_u32 m0, s89, 2048
  s_nop 0
  buffer_load_dwordx4 v245, s[28:31], s83 offen offset:1024 lds
  v_mfma_f32_32x32x16_bf16 v[6:21], a[228:231], v[190:193], v[6:21]
  ds_read_b128 a[252:255], v236 offset:0
  s_waitcnt vmcnt(11)
  ds_read_b64_tr_b16 a[160:161], v238 offset:2048
  ds_read_b64_tr_b16 a[162:163], v238 offset:3072
  ds_read_b64_tr_b16 a[164:165], v232 offset:2048
  ds_read_b64_tr_b16 a[166:167], v232 offset:3072
  s_waitcnt lgkmcnt(12)
  v_mfma_f32_32x32x16_bf16 v[6:21], a[232:235], v[194:197], v[6:21]
  ds_read_b128 a[224:227], v236 offset:1024
  s_waitcnt lgkmcnt(9)
  s_add_u32 m0, s95, 98304
  s_add_u32 s83, s88, 327680
  buffer_load_dwordx4 v246, s[28:31], s83 offen lds
  v_mfma_f32_32x32x16_bf16 v[6:21], a[236:239], v[198:201], v[6:21]
  ds_read_b128 a[228:231], v236 offset:2048
  s_waitcnt lgkmcnt(8)
  v_mfma_f32_32x32x16_bf16 v[6:21], a[240:243], v[202:205], v[6:21]
  ds_read_b128 a[232:235], v236 offset:3072
  s_mov_b32 s65, 393216
  buffer_load_dword v240, v241, s[44:47], s65 offen sc1
  v_mfma_f32_32x32x16_bf16 v[6:21], a[244:247], v[206:209], v[6:21]
  ds_read_b128 a[236:239], v236 offset:4096
  s_waitcnt vmcnt(11)
  ds_read_b64_tr_b16 a[168:169], v244 offset:4096
  ds_read_b64_tr_b16 a[170:171], v244 offset:5120
  ds_read_b64_tr_b16 a[172:173], v243 offset:4096
  ds_read_b64_tr_b16 a[174:175], v243 offset:5120
  s_waitcnt lgkmcnt(12)
  v_mfma_f32_32x32x16_bf16 v[22:37], a[248:251], v[210:213], 0
  ds_read_b128 a[240:243], v236 offset:5120
  s_add_u32 m0, s95, 98304
  s_nop 0
  buffer_load_dwordx4 v245, s[28:31], s83 offen offset:1024 lds
  v_mfma_f32_32x32x16_bf16 v[22:37], a[252:255], v[2:5], v[22:37]
  ds_read_b128 a[244:247], v236 offset:6144
  s_waitcnt lgkmcnt(8)
  v_mfma_f32_32x32x16_bf16 v[22:37], a[224:227], v[86:89], v[22:37]
  ds_read_b128 a[248:251], v236 offset:7168
  s_add_u32 m0, s95, 100352
  s_add_u32 s83, s88, 442368
  buffer_load_dwordx4 v246, s[28:31], s83 offen lds
  v_mfma_f32_32x32x16_bf16 v[22:37], a[228:231], v[90:93], v[22:37]
  ds_read_b128 a[252:255], v236 offset:8192
  s_waitcnt vmcnt(11)
  ds_read_b64_tr_b16 a[176:177], v238 offset:16384
  ds_read_b64_tr_b16 a[178:179], v238 offset:17408
  ds_read_b64_tr_b16 a[180:181], v232 offset:16384
  ds_read_b64_tr_b16 a[182:183], v232 offset:17408
  s_waitcnt lgkmcnt(12)
  v_mfma_f32_32x32x16_bf16 v[22:37], a[232:235], v[94:97], v[22:37]
  ds_read_b128 a[224:227], v236 offset:9216
  s_waitcnt vmcnt(8)
  s_mov_b32 s65, 425984
  buffer_store_dword v253, v233, s[44:47], s65 offen sc1
  v_mul_f32 v6, v6, v14
  v_mul_f32 v7, v7, v15
  v_mfma_f32_32x32x16_bf16 v[22:37], a[236:239], v[98:101], v[22:37]
  ds_read_b128 a[228:231], v236 offset:10240
  v_mul_f32 v8, v8, v16
  v_mul_f32 v9, v9, v17
  v_mul_f32 v10, v10, v18
  v_mul_f32 v11, v11, v19
  s_waitcnt lgkmcnt(8)
  v_mfma_f32_32x32x16_bf16 v[22:37], a[240:243], v[102:105], v[22:37]
  ds_read_b128 a[232:235], v236 offset:11264
  s_add_u32 m0, s95, 100352
  s_nop 0
  buffer_load_dwordx4 v245, s[28:31], s83 offen offset:1024 lds
  v_mfma_f32_32x32x16_bf16 v[22:37], a[244:247], v[106:109], v[22:37]
  ds_read_b128 a[236:239], v236 offset:12288
  ds_read_b64_tr_b16 a[184:185], v238 offset:18432
  ds_read_b64_tr_b16 a[186:187], v238 offset:19456
  ds_read_b64_tr_b16 a[188:189], v232 offset:18432
  ds_read_b64_tr_b16 a[190:191], v232 offset:19456
  s_waitcnt lgkmcnt(12)
  v_mfma_f32_32x32x16_bf16 v[22:37], a[248:251], v[110:113], v[22:37]
  ds_read_b128 a[240:243], v236 offset:13312
  v_mul_f32 v12, v12, v20
  v_mul_f32 v13, v13, v21
  v_mul_f32 v6, v6, v239
  v_mul_f32 v7, v7, v239
  v_mfma_f32_32x32x16_bf16 v[22:37], a[252:255], v[114:117], v[22:37]
  ds_read_b128 a[244:247], v236 offset:14336
  v_mul_f32 v8, v8, v239
  v_mul_f32 v9, v9, v239
  v_mul_f32 v10, v10, v239
  v_mul_f32 v11, v11, v239
  s_waitcnt lgkmcnt(8)
  v_mfma_f32_32x32x16_bf16 v[22:37], a[224:227], v[118:121], v[22:37]
  ds_read_b128 a[248:251], v236 offset:15360
  v_mul_f32 v12, v12, v239
  v_mul_f32 v13, v13, v239
  v_cvt_pk_bf16_f32 v214, v6, v7
  v_cvt_pk_bf16_f32 v215, v8, v9
  v_mfma_f32_32x32x16_bf16 v[22:37], a[228:231], v[122:125], v[22:37]
  ds_read_b128 a[252:255], v236 offset:16384
  v_cvt_pk_bf16_f32 v216, v10, v11
  v_cvt_pk_bf16_f32 v217, v12, v13
  buffer_store_dwordx4 v[214:217], v234, s[44:47], s11 offen offset:1024 sc0 sc1
  s_waitcnt lgkmcnt(8)
  v_mfma_f32_32x32x16_bf16 v[22:37], a[232:235], v[126:129], v[22:37]
  ds_read_b128 a[224:227], v236 offset:17408
  s_waitcnt vmcnt(5)
chk_32:
  v_cmp_ne_u32 vcc, v240, v253
  s_nop 4
  s_cbranch_vccz ok_34
slow_33:
  s_add_u32 s58, s58, 1
  s_cmp_gt_u32 s58, 200000
  s_cbranch_scc1 ok_34
  s_mov_b32 s65, 393216
  buffer_load_dword v240, v241, s[44:47], s65 offen sc1
  s_waitcnt vmcnt(0)
  s_branch chk_32
ok_34:
  v_mfma_f32_32x32x16_bf16 v[22:37], a[236:239], v[130:133], v[22:37]
  ds_read_b128 a[228:231], v236 offset:18432
  s_lshl_b32 s59, s14, 15
  s_lshl_b32 s60, s96, 6
  s_add_u32 s59, s59, s60
  s_add_u32 s59, s59, 9437184
  v_lshl_add_u32 v249, v252, 9, v254
  buffer_load_dwordx4 v[218:221], v249, s[44:47], s59 offen offset:0 sc1
  buffer_load_dwordx4 v[222:225], v249, s[44:47], s59 offen offset:512 sc1
  s_waitcnt lgkmcnt(4)
  v_mfma_f32_32x32x16_bf16 v[22:37], a[240:243], v[134:137], v[22:37]
  ds_read_b128 a[232:235], v236 offset:19456
  v_mfma_f32_32x32x16_bf16 v[22:37], a[244:247], v[138:141], v[22:37]
  ds_read_b128 a[236:239], v236 offset:20480
  s_add_u32 s59, s15, 0
  buffer_load_dwordx4 v[2:5], v254, s[44:47], s59 offen sc1
  s_waitcnt lgkmcnt(4)
  v_mfma_f32_32x32x16_bf16 v[22:37], a[248:251], v[142:145], v[22:37]
  ds_read_b128 a[240:243], v236 offset:21504
  ds_read_b64_tr_b16 a[192:193], v244 offset:0
  ds_read_b64_tr_b16 a[194:195], v244 offset:1024
  ds_read_b64_tr_b16 a[196:197], v243 offset:0
  ds_read_b64_tr_b16 a[198:199], v243 offset:1024
  v_mfma_f32_32x32x16_bf16 v[22:37], a[252:255], v[146:149], v[22:37]
  ds_read_b128 a[244:247], v236 offset:22528
  s_add_u32 s59, s16, 0
  buffer_load_dwordx4 v[86:89], v254, s[44:47], s59 offen sc1
  s_waitcnt lgkmcnt(8)
  v_mfma_f32_32x32x16_bf16 v[22:37], a[224:227], v[150:153], v[22:37]
  ds_read_b128 a[248:251], v236 offset:23552
  ds_read_b64_tr_b16 a[200:201], v244 offset:2048
  ds_read_b64_tr_b16 a[202:203], v244 offset:3072
  ds_read_b64_tr_b16 a[204:205], v243 offset:2048
  ds_read_b64_tr_b16 a[206:207], v243 offset:3072
  v_mfma_f32_32x32x16_bf16 v[22:37], a[228:231], v[154:157], v[22:37]
  ds_read_b128 a[252:255], v236 offset:24576
  s_add_u32 s59, s15, 1024
  buffer_load_dwordx4 v[90:93], v254, s[44:47], s59 offen sc1
  s_waitcnt lgkmcnt(12)
  v_mfma_f32_32x32x16_bf16 v[22:37], a[232:235], v[158:161], v[22:37]
  ds_read_b128 a[224:227], v236 offset:25600
  v_mfma_f32_32x32x16_bf16 v[22:37], a[236:239], v[162:165], v[22:37]
  ds_read_b128 a[228:231], v236 offset:26624
  s_add_u32 s59, s16, 1024
  buffer_load_dwordx4 v[94:97], v254, s[44:47], s59 offen sc1
  s_waitcnt lgkmcnt(8)
  v_mfma_f32_32x32x16_bf16 v[22:37], a[240:243], v[166:169], v[22:37]
  ds_read_b128 a[232:235], v236 offset:27648
  v_mfma_f32_32x32x16_bf16 v[22:37], a[244:247], v[170:173], v[22:37]
  ds_read_b128 a[236:239], v236 offset:28672
  s_add_u32 s59, s15, 2048
  buffer_load_dwordx4 v[98:101], v254, s[44:47], s59 offen sc1
  s_waitcnt lgkmcnt(4)
  v_mfma_f32_32x32x16_bf16 v[22:37], a[248:251], v[174:177], v[22:37]
  ds_read_b128 a[240:243], v236 offset:29696
  s_waitcnt vmcnt(11)
  ds_read_b64_tr_b16 a[208:209], v238 offset:0
  ds_read_b64_tr_b16 a[210:211], v238 offset:1024
  ds_read_b64_tr_b16 a[212:213], v232 offset:0
  ds_read_b64_tr_b16 a[214:215], v232 offset:1024
  v_mfma_f32_32x32x16_bf16 v[22:37], a[252:255], v[178:181], v[22:37]
  ds_read_b128 a[244:247], v236 offset:30720
  s_add_u32 s59, s16, 2048
  buffer_load_dwordx4 v[102:105], v254, s[44:47], s59 offen sc1
  s_waitcnt lgkmcnt(8)
  v_mfma_f32_32x32x16_bf16 v[22:37], a[224:227], v[182:185], v[22:37]
  ds_read_b128 a[248:251], v236 offset:31744
  v_mfma_f32_32x32x16_bf16 v[22:37], a[228:231], v[186:189], v[22:37]
  s_add_u32 s59, s15, 7168
  buffer_load_dwordx4 v[106:109], v254, s[44:47], s59 offen sc1
  s_waitcnt lgkmcnt(7)
  v_mfma_f32_32x32x16_bf16 v[22:37], a[232:235], v[190:193], v[22:37]
  v_mfma_f32_32x32x16_bf16 v[22:37], a[236:239], v[194:197], v[22:37]
  s_waitcnt vmcnt(9)
  s_mov_b32 s65, 458752
  buffer_store_dword v253, v233, s[44:47], s65 offen sc1
  s_waitcnt lgkmcnt(1)
  v_mfma_f32_32x32x16_bf16 v[22:37], a[240:243], v[198:201], v[22:37]
  ds_read_b64_tr_b16 a[216:217], v238 offset:2048
  ds_read_b64_tr_b16 a[218:219], v238 offset:3072
  ds_read_b64_tr_b16 a[220:221], v232 offset:2048
  ds_read_b64_tr_b16 a[222:223], v232 offset:3072
  v_mfma_f32_32x32x16_bf16 v[22:37], a[244:247], v[202:205], v[22:37]
  s_add_u32 s59, s16, 7168
  buffer_load_dwordx4 v[110:113], v254, s[44:47], s59 offen sc1
  s_waitcnt lgkmcnt(4)
  v_mfma_f32_32x32x16_bf16 v[22:37], a[248:251], v[206:209], v[22:37]
  s_add_u32 s59, s15, 8192
  buffer_load_dwordx4 v[114:117], v254, s[44:47], s59 offen sc1
  s_add_u32 s59, s16, 8192
  buffer_load_dwordx4 v[118:121], v254, s[44:47], s59 offen sc1
  s_nop 7
  v_mul_f32 v22, v22, v30
  v_mul_f32 v23, v23, v31
  v_mul_f32 v24, v24, v32
  v_mul_f32 v25, v25, v33
  v_mul_f32 v26, v26, v34
  v_mul_f32 v27, v27, v35
  v_mul_f32 v28, v28, v36
  v_mul_f32 v29, v29, v37
  v_mul_f32 v22, v22, v239
  v_mul_f32 v23, v23, v239
  v_mul_f32 v24, v24, v239
  v_mul_f32 v25, v25, v239
  v_mul_f32 v26, v26, v239
  v_mul_f32 v27, v27, v239
  v_mul_f32 v28, v28, v239
  v_mul_f32 v29, v29, v239
  v_cvt_pk_bf16_f32 v214, v22, v23
  v_cvt_pk_bf16_f32 v215, v24, v25
  v_cvt_pk_bf16_f32 v216, v26, v27
  v_cvt_pk_bf16_f32 v217, v28, v29
  buffer_store_dwordx4 v[214:217], v234, s[44:47], s11 offen offset:2048 sc0 sc1
  s_barrier
  s_waitcnt vmcnt(11)
  v_mfma_f32_32x32x16_bf16 v[6:21], a[0:3], v[2:5], 0
  s_add_u32 s59, s15, 9216
  buffer_load_dwordx4 v[122:125], v254, s[44:47], s59 offen sc1
  v_mfma_f32_32x32x16_bf16 v[22:37], a[4:7], v[2:5], 0
  s_add_u32 s59, s16, 9216
  buffer_load_dwordx4 v[126:129], v254, s[44:47], s59 offen sc1
  s_waitcnt vmcnt(12)
  v_mfma_f32_32x32x16_bf16 v[38:53], a[0:3], v[86:89], 0
  s_add_u32 s59, s15, 14336
  buffer_load_dwordx4 v[130:133], v254, s[44:47], s59 offen sc1
  v_mfma_f32_32x32x16_bf16 v[54:69], a[4:7], v[86:89], 0
  s_add_u32 s59, s16, 14336
  buffer_load_dwordx4 v[134:137], v254, s[44:47], s59 offen sc1
  s_waitcnt vmcnt(13)
  v_mfma_f32_32x32x16_bf16 v[6:21], a[8:11], v[90:93], v[6:21]
  s_add_u32 s59, s15, 15360
  buffer_load_dwordx4 v[138:141], v254, s[44:47], s59 offen sc1
  v_mfma_f32_32x32x16_bf16 v[22:37], a[12:15], v[90:93], v[22:37]
  s_add_u32 s59, s16, 15360
  buffer_load_dwordx4 v[142:145], v254, s[44:47], s59 offen sc1
  s_waitcnt vmcnt(14)
  v_mfma_f32_32x32x16_bf16 v[38:53], a[8:11], v[94:97], v[38:53]
  v_mfma_f32_32x32x16_bf16 v[54:69], a[12:15], v[94:97], v[54:69]
  s_add_u32 s59, s15, 16384
  buffer_load_dwordx4 v[146:149], v254, s[44:47], s59 offen sc1
  s_waitcnt vmcnt(14)
  v_mfma_f32_32x32x16_bf16 v[6:21], a[16:19], v[98:101], v[6:21]
  s_add_u32 s59, s16, 16384
  buffer_load_dwordx4 v[150:153], v254, s[44:47], s59 offen sc1
  s_mov_b32 s65, 425984
  buffer_load_dword v240, v241, s[44:47], s65 offen sc1
  s_waitcnt vmcnt(9)
  s_mov_b32 s65, 491520
  buffer_store_dword v253, v233, s[44:47], s65 offen sc1
  v_lshl_add_u32 v249, v251, 2, s9
  ds_write_b32 v249, v242 offset:6144
  v_mfma_f32_32x32x16_bf16 v[22:37], a[20:23], v[98:101], v[22:37]
  s_add_u32 s59, s15, 21504
  buffer_load_dwordx4 v[154:157], v254, s[44:47], s59 offen sc1
  v_mfma_f32_32x32x16_bf16 v[38:53], a[16:19], v[102:105], v[38:53]
  v_mfma_f32_32x32x16_bf16 v[54:69], a[20:23], v[102:105], v[54:69]
  s_add_u32 s59, s16, 21504
  buffer_load_dwordx4 v[158:161], v254, s[44:47], s59 offen sc1
  v_mfma_f32_32x32x16_bf16 v[6:21], a[24:27], v[106:109], v[6:21]
  v_mfma_f32_32x32x16_bf16 v[22:37], a[28:31], v[106:109], v[22:37]
  s_add_u32 s59, s15, 22528
  buffer_load_dwordx4 v[162:165], v254, s[44:47], s59 offen sc1
  v_mfma_f32_32x32x16_bf16 v[38:53], a[24:27], v[110:113], v[38:53]
  v_mfma_f32_32x32x16_bf16 v[54:69], a[28:31], v[110:113], v[54:69]
  s_add_u32 s59, s16, 22528
  buffer_load_dwordx4 v[166:169], v254, s[44:47], s59 offen sc1
  v_mfma_f32_32x32x16_bf16 v[6:21], a[32:35], v[114:117], v[6:21]
  v_mfma_f32_32x32x16_bf16 v[22:37], a[36:39], v[114:117], v[22:37]
  s_add_u32 s59, s15, 23552
  buffer_load_dwordx4 v[170:173], v254, s[44:47], s59 offen sc1
  v_mfma_f32_32x32x16_bf16 v[38:53], a[32:35], v[118:121], v[38:53]
  v_mfma_f32_32x32x16_bf16 v[54:69], a[36:39], v[118:121], v[54:69]
  s_add_u32 s59, s16, 23552
  buffer_load_dwordx4 v[174:177], v254, s[44:47], s59 offen sc1
  s_waitcnt vmcnt(15)
  v_mfma_f32_32x32x16_bf16 v[6:21], a[40:43], v[122:125], v[6:21]
  v_mfma_f32_32x32x16_bf16 v[22:37], a[44:47], v[122:125], v[22:37]
  s_waitcnt vmcnt(14)
  v_mfma_f32_32x32x16_bf16 v[38:53], a[40:43], v[126:129], v[38:53]
  v_mfma_f32_32x32x16_bf16 v[54:69], a[44:47], v[126:129], v[54:69]
  s_waitcnt vmcnt(13)
  v_mfma_f32_32x32x16_bf16 v[6:21], a[48:51], v[130:133], v[6:21]
  v_mfma_f32_32x32x16_bf16 v[22:37], a[52:55], v[130:133], v[22:37]
  s_waitcnt vmcnt(12)
  v_mfma_f32_32x32x16_bf16 v[38:53], a[48:51], v[134:137], v[38:53]
  v_mfma_f32_32x32x16_bf16 v[54:69], a[52:55], v[134:137], v[54:69]
  s_waitcnt vmcnt(11)
  v_mfma_f32_32x32x16_bf16 v[6:21], a[56:59], v[138:141], v[6:21]
  s_waitcnt vmcnt(7)
chk_35:
  v_cmp_ne_u32 vcc, v240, v253
  s_nop 4
  s_cbranch_vccz ok_37
slow_36:
  s_add_u32 s58, s58, 1
  s_cmp_gt_u32 s58, 200000
  s_cbranch_scc1 ok_37
  s_mov_b32 s65, 425984
  buffer_load_dword v240, v241, s[44:47], s65 offen sc1
  s_waitcnt vmcnt(0)
  s_branch chk_35
ok_37:
  s_mov_b32 s65, 458752
  buffer_load_dword v240, v241, s[44:47], s65 offen sc1
  v_mfma_f32_32x32x16_bf16 v[22:37], a[60:63], v[138:141], v[22:37]
  s_add_u32 s59, s15, 3072
  buffer_load_dwordx4 v[178:181], v254, s[44:47], s59 offen sc1
  v_mfma_f32_32x32x16_bf16 v[38:53], a[56:59], v[142:145], v[38:53]
  s_add_u32 s59, s16, 3072
  buffer_load_dwordx4 v[182:185], v254, s[44:47], s59 offen sc1
  v_mfma_f32_32x32x16_bf16 v[54:69], a[60:63], v[142:145], v[54:69]
  s_add_u32 s59, s15, 4096
  buffer_load_dwordx4 v[186:189], v254, s[44:47], s59 offen sc1
  v_mfma_f32_32x32x16_bf16 v[6:21], a[64:67], v[146:149], v[6:21]
  s_add_u32 s59, s16, 4096
  buffer_load_dwordx4 v[190:193], v254, s[44:47], s59 offen sc1
  v_mfma_f32_32x32x16_bf16 v[22:37], a[68:71], v[146:149], v[22:37]
  s_add_u32 s59, s15, 10240
  buffer_load_dwordx4 v[194:197], v254, s[44:47], s59 offen sc1
  v_mfma_f32_32x32x16_bf16 v[38:53], a[64:67], v[150:153], v[38:53]
  s_add_u32 s59, s16, 10240
  buffer_load_dwordx4 v[198:201], v254, s[44:47], s59 offen sc1
  v_mfma_f32_32x32x16_bf16 v[54:69], a[68:71], v[150:153], v[54:69]
  s_add_u32 s59, s15, 11264
  buffer_load_dwordx4 v[202:205], v254, s[44:47], s59 offen sc1
  s_waitcnt vmcnt(13)
  v_mfma_f32_32x32x16_bf16 v[6:21], a[72:75], v[154:157], v[6:21]
  s_add_u32 s59, s16, 11264
  buffer_load_dwordx4 v[206:209], v254, s[44:47], s59 offen sc1
  v_mfma_f32_32x32x16_bf16 v[22:37], a[76:79], v[154:157], v[22:37]
  s_add_u32 s59, s15, 17408
  buffer_load_dwordx4 v[2:5], v254, s[44:47], s59 offen sc1
  s_waitcnt vmcnt(14)
  v_mfma_f32_32x32x16_bf16 v[38:53], a[72:75], v[158:161], v[38:53]
  v_mfma_f32_32x32x16_bf16 v[54:69], a[76:79], v[158:161], v[54:69]
  s_add_u32 s59, s16, 17408
  buffer_load_dwordx4 v[86:89], v254, s[44:47], s59 offen sc1
  s_waitcnt vmcnt(14)
  v_mfma_f32_32x32x16_bf16 v[6:21], a[80:83], v[162:165], v[6:21]
  v_mfma_f32_32x32x16_bf16 v[22:37], a[84:87], v[162:165], v[22:37]
  s_add_u32 s59, s15, 18432
  buffer_load_dwordx4 v[90:93], v254, s[44:47], s59 offen sc1
  s_waitcnt vmcnt(14)
  v_mfma_f32_32x32x16_bf16 v[38:53], a[80:83], v[166:169], v[38:53]
  v_mfma_f32_32x32x16_bf16 v[54:69], a[84:87], v[166:169], v[54:69]
  s_add_u32 s59, s16, 18432
  buffer_load_dwordx4 v[94:97], v254, s[44:47], s59 offen sc1
  s_waitcnt vmcnt(14)
  v_mfma_f32_32x32x16_bf16 v[6:21], a[88:91], v[170:173], v[6:21]
  v_mfma_f32_32x32x16_bf16 v[22:37], a[92:95], v[170:173], v[22:37]
  s_add_u32 s59, s15, 24576
  buffer_load_dwordx4 v[98:101], v254, s[44:47], s59 offen sc1
  s_waitcnt vmcnt(14)
  v_mfma_f32_32x32x16_bf16 v[38:53], a[88:91], v[174:177], v[38:53]
  v_mfma_f32_32x32x16_bf16 v[54:69], a[92:95], v[174:177], v[54:69]
  s_add_u32 s59, s16, 24576
  buffer_load_dwordx4 v[102:105], v254, s[44:47], s59 offen sc1
  s_waitcnt vmcnt(13)
  v_mfma_f32_32x32x16_bf16 v[6:21], a[96:99], v[178:181], v[6:21]
chk_38:
  s_branch L_pskip3
.p2align 12
L_pstub3:
  s_branch L_pback3
L_pskip3:
  v_cmp_ne_u32 vcc, v240, v253
  s_nop 4
  s_cbranch_vccz ok_40
slow_39:
  s_add_u32 s58, s58, 1
  s_cmp_gt_u32 s58, 200000
  s_cbranch_scc1 ok_40
  s_mov_b32 s65, 458752
  buffer_load_dword v240, v241, s[44:47], s65 offen sc1
  s_waitcnt vmcnt(0)
  s_branch chk_38
ok_40:
  v_mfma_f32_32x32x16_bf16 v[22:37], a[100:103], v[178:181], v[22:37]
  s_add_u32 s59, s15, 25600
  buffer_load_dwordx4 v[106:109], v254, s[44:47], s59 offen sc1
  s_waitcnt vmcnt(13)
  v_mfma_f32_32x32x16_bf16 v[38:53], a[96:99], v[182:185], v[38:53]
  v_mfma_f32_32x32x16_bf16 v[54:69], a[100:103], v[182:185], v[54:69]
  s_add_u32 s59, s16, 25600
  buffer_load_dwordx4 v[110:113], v254, s[44:47], s59 offen sc1
  s_waitcnt vmcnt(13)
  v_mfma_f32_32x32x16_bf16 v[6:21], a[104:107], v[186:189], v[6:21]
  s_mov_b32 s65, 491520
  buffer_load_dword v240, v241, s[44:47], s65 offen sc1
  v_mfma_f32_32x32x16_bf16 v[22:37], a[108:111], v[186:189], v[22:37]
  s_add_u32 s59, s15, 5120
  buffer_load_dwordx4 v[114:117], v254, s[44:47], s59 offen sc1
  s_waitcnt vmcnt(14)
  v_mfma_f32_32x32x16_bf16 v[38:53], a[104:107], v[190:193], v[38:53]
  v_mfma_f32_32x32x16_bf16 v[54:69], a[108:111], v[190:193], v[54:69]
  s_add_u32 s59, s16, 5120
  buffer_load_dwordx4 v[118:121], v254, s[44:47], s59 offen sc1
  s_waitcnt vmcnt(14)
  v_mfma_f32_32x32x16_bf16 v[6:21], a[112:115], v[194:197], v[6:21]
  v_mfma_f32_32x32x16_bf16 v[22:37], a[116:119], v[194:197], v[22:37]
  s_add_u32 s59, s15, 12288
  buffer_load_dwordx4 v[122:125], v254, s[44:47], s59 offen sc1
  s_waitcnt vmcnt(14)
  v_mfma_f32_32x32x16_bf16 v[38:53], a[112:115], v[198:201], v[38:53]
  v_mfma_f32_32x32x16_bf16 v[54:69], a[116:119], v[198:201], v[54:69]
  s_add_u32 s59, s16, 12288
  buffer_load_dwordx4 v[126:129], v254, s[44:47], s59 offen sc1
  s_waitcnt vmcnt(14)
  v_mfma_f32_32x32x16_bf16 v[6:21], a[120:123], v[202:205], v[6:21]
  v_mfma_f32_32x32x16_bf16 v[22:37], a[124:127], v[202:205], v[22:37]
  s_add_u32 s59, s15, 19456
  buffer_load_dwordx4 v[130:133], v254, s[44:47], s59 offen sc1
  s_waitcnt vmcnt(14)
  v_mfma_f32_32x32x16_bf16 v[38:53], a[120:123], v[206:209], v[38:53]
  v_mfma_f32_32x32x16_bf16 v[54:69], a[124:127], v[206:209], v[54:69]
  s_add_u32 s59, s16, 19456
  buffer_load_dwordx4 v[134:137], v254, s[44:47], s59 offen sc1
  s_waitcnt vmcnt(14)
  v_mfma_f32_32x32x16_bf16 v[6:21], a[128:131], v[2:5], v[6:21]
  v_mfma_f32_32x32x16_bf16 v[22:37], a[132:135], v[2:5], v[22:37]
  s_add_u32 s59, s15, 26624
  buffer_load_dwordx4 v[138:141], v254, s[44:47], s59 offen sc1
  s_waitcnt vmcnt(14)
  v_mfma_f32_32x32x16_bf16 v[38:53], a[128:131], v[86:89], v[38:53]
  v_mfma_f32_32x32x16_bf16 v[54:69], a[132:135], v[86:89], v[54:69]
  s_add_u32 s59, s16, 26624
  buffer_load_dwordx4 v[142:145], v254, s[44:47], s59 offen sc1
  s_waitcnt vmcnt(14)
  v_mfma_f32_32x32x16_bf16 v[6:21], a[136:139], v[90:93], v[6:21]
  v_mfma_f32_32x32x16_bf16 v[22:37], a[140:143], v[90:93], v[22:37]
  s_waitcnt vmcnt(13)
  v_mfma_f32_32x32x16_bf16 v[38:53], a[136:139], v[94:97], v[38:53]
  v_mfma_f32_32x32x16_bf16 v[54:69], a[140:143], v[94:97], v[54:69]
  s_waitcnt vmcnt(12)
  v_mfma_f32_32x32x16_bf16 v[6:21], a[144:147], v[98:101], v[6:21]
  s_waitcnt vmcnt(8)
chk_41:
  v_cmp_ne_u32 vcc, v240, v253
  s_nop 4
  s_cbranch_vccz ok_43
slow_42:
  s_add_u32 s58, s58, 1
  s_cmp_gt_u32 s58, 200000
  s_cbranch_scc1 ok_43
  s_mov_b32 s65, 491520
  buffer_load_dword v240, v241, s[44:47], s65 offen sc1
  s_waitcnt vmcnt(0)
  s_branch chk_41
ok_43:
  v_mfma_f32_32x32x16_bf16 v[22:37], a[148:151], v[98:101], v[22:37]
  s_add_u32 s59, s15, 6144
  buffer_load_dwordx4 v[146:149], v254, s[44:47], s59 offen sc1
  v_mfma_f32_32x32x16_bf16 v[38:53], a[144:147], v[102:105], v[38:53]
  s_add_u32 s59, s16, 6144
  buffer_load_dwordx4 v[150:153], v254, s[44:47], s59 offen sc1
  v_mfma_f32_32x32x16_bf16 v[54:69], a[148:151], v[102:105], v[54:69]
  s_add_u32 s59, s15, 13312
  buffer_load_dwordx4 v[154:157], v254, s[44:47], s59 offen sc1
  v_mfma_f32_32x32x16_bf16 v[6:21], a[152:155], v[106:109], v[6:21]
  s_add_u32 s59, s16, 13312
  buffer_load_dwordx4 v[158:161], v254, s[44:47], s59 offen sc1
  v_mfma_f32_32x32x16_bf16 v[22:37], a[156:159], v[106:109], v[22:37]
  s_add_u32 s59, s15, 20480
  buffer_load_dwordx4 v[162:165], v254, s[44:47], s59 offen sc1
  v_mfma_f32_32x32x16_bf16 v[38:53], a[152:155], v[110:113], v[38:53]
  v_mfma_f32_32x32x16_bf16 v[54:69], a[156:159], v[110:113], v[54:69]
  s_add_u32 s59, s16, 20480
  buffer_load_dwordx4 v[166:169], v254, s[44:47], s59 offen sc1
  s_waitcnt vmcnt(13)
  v_mfma_f32_32x32x16_bf16 v[6:21], a[160:163], v[114:117], v[6:21]
  v_mfma_f32_32x32x16_bf16 v[22:37], a[164:167], v[114:117], v[22:37]
  s_add_u32 s59, s15, 27648
  buffer_load_dwordx4 v[170:173], v254, s[44:47], s59 offen sc1
  s_waitcnt vmcnt(13)
  v_mfma_f32_32x32x16_bf16 v[38:53], a[160:163], v[118:121], v[38:53]
  v_mfma_f32_32x32x16_bf16 v[54:69], a[164:167], v[118:121], v[54:69]
  s_add_u32 s59, s16, 27648
  buffer_load_dwordx4 v[174:177], v254, s[44:47], s59 offen sc1
  s_waitcnt vmcnt(13)
  v_mfma_f32_32x32x16_bf16 v[6:21], a[168:171], v[122:125], v[6:21]
  v_lshlrev_b32 v248, 6, v252
  v_add_u32 v248, s9, v248
  ds_read_b128 v[118:121], v248 offset:6144
  ds_read_b128 v[114:117], v248 offset:6160
  ds_read_b128 v[110:113], v248 offset:6176
  ds_read_b128 v[106:109], v248 offset:6192
  v_lshlrev_b32 v102, 16, v218
  v_and_b32 v103, s70, v218
  v_mfma_f32_32x32x16_bf16 v[22:37], a[172:175], v[122:125], v[22:37]
  v_lshlrev_b32 v104, 16, v219
  v_and_b32 v105, s70, v219
  s_waitcnt vmcnt(12)
  v_mfma_f32_32x32x16_bf16 v[38:53], a[168:171], v[126:129], v[38:53]
  v_lshlrev_b32 v98, 16, v220
  v_and_b32 v99, s70, v220
  v_mfma_f32_32x32x16_bf16 v[54:69], a[172:175], v[126:129], v[54:69]
  v_lshlrev_b32 v100, 16, v221
  v_and_b32 v101, s70, v221
  s_waitcnt vmcnt(11)
  v_mfma_f32_32x32x16_bf16 v[6:21], a[176:179], v[130:133], v[6:21]
  v_lshlrev_b32 v94, 16, v222
  v_and_b32 v95, s70, v222
  v_mfma_f32_32x32x16_bf16 v[22:37], a[180:183], v[130:133], v[22:37]
  v_lshlrev_b32 v96, 16, v223
  v_and_b32 v97, s70, v223
  s_waitcnt vmcnt(10)
  v_mfma_f32_32x32x16_bf16 v[38:53], a[176:179], v[134:137], v[38:53]
  v_lshlrev_b32 v90, 16, v224
  v_and_b32 v91, s70, v224
  v_mfma_f32_32x32x16_bf16 v[54:69], a[180:183], v[134:137], v[54:69]
  v_lshlrev_b32 v92, 16, v225
  v_and_b32 v93, s70, v225
  s_waitcnt vmcnt(9)
  v_mfma_f32_32x32x16_bf16 v[6:21], a[184:187], v[138:141], v[6:21]
  s_xor_b32 s59, s57, 1
  s_mul_i32 s59, s59, 12288
  v_add_u32 v135, s59, v254
  v_mfma_f32_32x32x16_bf16 v[22:37], a[188:191], v[138:141], v[22:37]
  s_xor_b32 s59, s57, 2
  s_mul_i32 s59, s59, 12288
  v_add_u32 v136, s59, v254
  s_waitcnt vmcnt(8)
  v_mfma_f32_32x32x16_bf16 v[38:53], a[184:187], v[142:145], v[38:53]
  s_xor_b32 s59, s57, 3
  s_mul_i32 s59, s59, 12288
  v_add_u32 v137, s59, v254
  v_mfma_f32_32x32x16_bf16 v[54:69], a[188:191], v[142:145], v[54:69]
  s_mul_i32 s59, s57, 12288
  v_add_u32 v134, s59, v254
  s_waitcnt vmcnt(7)
  v_mfma_f32_32x32x16_bf16 v[22:37], a[196:199], v[146:149], v[22:37]
  s_lshl_b32 s61, s14, 15
  s_lshl_b32 s60, s96, 1
  s_add_u32 s61, s61, s60
  s_add_u32 s62, s61, 16384
  s_waitcnt vmcnt(5)
  v_mfma_f32_32x32x16_bf16 v[22:37], a[204:207], v[154:157], v[22:37]
  v_lshrrev_b32 v248, 2, v255
  v_lshlrev_b32 v248, 10, v248
  v_and_b32 v247, 3, v255
  v_lshl_add_u32 v248, v247, 4, v248
  s_waitcnt vmcnt(3)
  v_mfma_f32_32x32x16_bf16 v[22:37], a[212:215], v[162:165], v[22:37]
  v_lshlrev_b32 v247, 6, v251
  v_lshl_add_u32 v247, v252, 5, v247
  v_add_u32 v247, s9, v247
  v_add_u32 v249, s9, v254
  s_waitcnt vmcnt(1) lgkmcnt(5)
  v_mfma_f32_32x32x16_bf16 v[22:37], a[220:223], v[170:173], v[22:37]
  v_mfma_f32_32x32x16_bf16 v[38:53], a[192:195], v[150:153], v[38:53]
  v_mfma_f32_32x32x16_bf16 v[38:53], a[200:203], v[158:161], v[38:53]
  s_nop 9
  ds_write_b128 v135, v[22:25] offset:0
  v_mfma_f32_32x32x16_bf16 v[38:53], a[208:211], v[166:169], v[38:53]
  ds_write_b128 v135, v[26:29] offset:1024
  s_waitcnt vmcnt(0)
  v_mfma_f32_32x32x16_bf16 v[38:53], a[216:219], v[174:177], v[38:53]
  ds_write_b128 v135, v[30:33] offset:2048
  v_mfma_f32_32x32x16_bf16 v[54:69], a[196:199], v[150:153], v[54:69]
  ds_write_b128 v135, v[34:37] offset:3072
  v_mfma_f32_32x32x16_bf16 v[54:69], a[204:207], v[158:161], v[54:69]
  s_nop 7
  ds_write_b128 v136, v[38:41] offset:4096
  v_mfma_f32_32x32x16_bf16 v[54:69], a[212:215], v[166:169], v[54:69]
  ds_write_b128 v136, v[42:45] offset:5120
  v_mfma_f32_32x32x16_bf16 v[54:69], a[220:223], v[174:177], v[54:69]
  ds_write_b128 v136, v[46:49] offset:6144
  v_mfma_f32_32x32x16_bf16 v[6:21], a[192:195], v[146:149], v[6:21]
  ds_write_b128 v136, v[50:53] offset:7168
  v_mfma_f32_32x32x16_bf16 v[6:21], a[200:203], v[154:157], v[6:21]
  s_nop 7
  ds_write_b128 v137, v[54:57] offset:8192
  v_mfma_f32_32x32x16_bf16 v[6:21], a[208:211], v[162:165], v[6:21]
  ds_write_b128 v137, v[58:61] offset:9216
  v_mfma_f32_32x32x16_bf16 v[6:21], a[216:219], v[170:173], v[6:21]
  ds_write_b128 v137, v[62:65] offset:10240
  ds_write_b128 v137, v[66:69] offset:11264
  s_waitcnt lgkmcnt(0)
  s_barrier
  ds_read_b128 v[22:25], v134 offset:0
  ds_read_b128 v[38:41], v134 offset:4096
  ds_read_b128 v[54:57], v134 offset:8192
  ds_read_b128 v[26:29], v134 offset:1024
  ds_read_b128 v[42:45], v134 offset:5120
  ds_read_b128 v[58:61], v134 offset:9216
  ds_read_b128 v[30:33], v134 offset:2048
  ds_read_b128 v[46:49], v134 offset:6144
  ds_read_b128 v[62:65], v134 offset:10240
  ds_read_b128 v[34:37], v134 offset:3072
  ds_read_b128 v[50:53], v134 offset:7168
  ds_read_b128 v[66:69], v134 offset:11264
  s_waitcnt lgkmcnt(9)
  v_pk_add_f32 v[22:23], v[22:23], v[38:39]
  v_pk_add_f32 v[24:25], v[24:25], v[40:41]
  v_pk_add_f32 v[6:7], v[6:7], v[54:55]
  v_pk_add_f32 v[8:9], v[8:9], v[56:57]
  v_pk_add_f32 v[6:7], v[6:7], v[22:23]
  v_pk_add_f32 v[8:9], v[8:9], v[24:25]
  v_pk_fma_f32 v[102:103], v[6:7], v[118:119], v[102:103]
  v_pk_fma_f32 v[104:105], v[8:9], v[120:121], v[104:105]
  v_cvt_pk_bf16_f32 v218, v102, v103
  v_cvt_pk_bf16_f32 v219, v104, v105
  s_waitcnt lgkmcnt(6)
  v_pk_add_f32 v[26:27], v[26:27], v[42:43]
  v_pk_add_f32 v[28:29], v[28:29], v[44:45]
  v_pk_add_f32 v[10:11], v[10:11], v[58:59]
  v_pk_add_f32 v[12:13], v[12:13], v[60:61]
  v_pk_add_f32 v[10:11], v[10:11], v[26:27]
  v_pk_add_f32 v[12:13], v[12:13], v[28:29]
  v_pk_fma_f32 v[98:99], v[10:11], v[114:115], v[98:99]
  v_pk_fma_f32 v[100:101], v[12:13], v[116:117], v[100:101]
  v_cvt_pk_bf16_f32 v220, v98, v99
  v_cvt_pk_bf16_f32 v221, v100, v101
  ds_write_b128 v247, v[218:221] offset:4096
  s_waitcnt lgkmcnt(4)
  v_pk_add_f32 v[30:31], v[30:31], v[46:47]
  v_pk_add_f32 v[32:33], v[32:33], v[48:49]
  v_pk_add_f32 v[14:15], v[14:15], v[62:63]
  v_pk_add_f32 v[16:17], v[16:17], v[64:65]
  v_pk_add_f32 v[14:15], v[14:15], v[30:31]
  v_pk_add_f32 v[16:17], v[16:17], v[32:33]
  v_pk_fma_f32 v[94:95], v[14:15], v[110:111], v[94:95]
  v_pk_fma_f32 v[96:97], v[16:17], v[112:113], v[96:97]
  v_cvt_pk_bf16_f32 v222, v94, v95
  v_cvt_pk_bf16_f32 v223, v96, v97
  s_waitcnt lgkmcnt(1)
  v_pk_add_f32 v[34:35], v[34:35], v[50:51]
  v_pk_add_f32 v[36:37], v[36:37], v[52:53]
  v_pk_add_f32 v[18:19], v[18:19], v[66:67]
  v_pk_add_f32 v[20:21], v[20:21], v[68:69]
  v_pk_add_f32 v[18:19], v[18:19], v[34:35]
  v_pk_add_f32 v[20:21], v[20:21], v[36:37]
  v_pk_fma_f32 v[90:91], v[18:19], v[106:107], v[90:91]
  v_pk_fma_f32 v[92:93], v[20:21], v[108:109], v[92:93]
  v_cvt_pk_bf16_f32 v224, v90, v91
  v_cvt_pk_bf16_f32 v225, v92, v93
  ds_write_b128 v247, v[222:225] offset:4112
  ds_read_b128 v[118:121], v249 offset:4096
  ds_read_b128 v[114:117], v249 offset:5120
  s_waitcnt lgkmcnt(1)
  buffer_store_dwordx4 v[118:121], v248, s[40:43], s61 offen
  s_waitcnt lgkmcnt(0)
  buffer_store_dwordx4 v[114:117], v248, s[40:43], s62 offen
L_end:
  s_endpgm
.section .rodata,"a"
.p2align 6
.amdhsa_kernel adaLN_cond__ssm_conv_h3__glu_gated_bilinear__prompt_kernel
  .amdhsa_next_free_vgpr 512
  .amdhsa_next_free_sgpr 102
  .amdhsa_accum_offset 256
  .amdhsa_group_segment_fixed_size 0
  .amdhsa_kernarg_size 120
  .amdhsa_user_sgpr_count 2
  .amdhsa_user_sgpr_kernarg_segment_ptr 1
  .amdhsa_system_sgpr_workgroup_id_x 1
.end_amdhsa_kernel
```
